```python
import torch

def _softmax(x, axis=-1):
    return torch.softmax(x, dim=axis)
def _gelu(x):
    return torch.nn.functional.gelu(x, approximate="tanh")
def _silu(x):
    return torch.nn.functional.silu(x)
def _sigmoid(x):
    return torch.sigmoid(x)
def _layernorm(x, axis=-1, eps=1e-5):
    m = x.mean(dim=axis, keepdim=True)
    v = x.var(dim=axis, keepdim=True, unbiased=False)
    return (x - m) / torch.sqrt(v + eps)
def _scatter_add(tgt, idx, src, axis=0):
    return tgt.clone().index_add_(axis, idx, src)
def _segment_sum(src, seg, n):
    out = torch.zeros((n,) + src.shape[1:], dtype=src.dtype)
    return out.index_add_(0, seg, src)
def _pad(x, pw):
    flat = tuple(v for pair in reversed(pw) for v in pair)
    return torch.nn.functional.pad(x, flat)

kernel_name = 'gated_mix__linear_kernel_hedgehog__grouped_kv_mqa__prompt'

def setup_inputs():

    _w = (lambda a: (lambda t: t.to(torch.bfloat16) if t.is_floating_point() else t)(torch.as_tensor(a)))
    def _A_setup():
        B, S, D, H = 1, 2048, 512, 32
        Dh = D // H
        return {
            "x": _w((lambda *s: torch.randn(*s, dtype=torch.bfloat16) * 0.05)(B, S, D)),
            "wqkv": _w((lambda *s: torch.randn(*s, dtype=torch.bfloat16) * 1.6)(D, 3 * D)),
            "w_phi": _w((lambda *s: torch.randn(*s, dtype=torch.bfloat16) * 1.6)(H, Dh, Dh) * (Dh ** -0.5)),
            "wo": _w((lambda *s: torch.randn(*s, dtype=torch.bfloat16) * 0.4)(D, D)),
        }
    _A_in = _A_setup()

    def _B_setup():
        B, S, D, H = 1, 2048, 512, 32
        Dh = D // H
        return {
            "x": _w((lambda *s: torch.randn(*s, dtype=torch.bfloat16) * 0.05)(B, S, D)),
            "wq": _w((lambda *s: torch.randn(*s, dtype=torch.bfloat16) * 3.2)(D, H * Dh)),
            "wk": _w((lambda *s: torch.randn(*s, dtype=torch.bfloat16) * 3.2)(D, Dh)),
            "wv": _w((lambda *s: torch.randn(*s, dtype=torch.bfloat16) * 0.1)(D, Dh)),
            "wo": _w((lambda *s: torch.randn(*s, dtype=torch.bfloat16) * 0.1)(H * Dh, D)),
        }
    _B_in = _B_setup()

    return {
        "A_x": _A_in["x"],
        "A_wqkv": _A_in["wqkv"],
        "A_w_phi": _A_in["w_phi"],
        "A_wo": _A_in["wo"],
        "B_x": _B_in["x"],
        "B_wq": _B_in["wq"],
        "B_wk": _B_in["wk"],
        "B_wv": _B_in["wv"],
        "B_wo": _B_in["wo"],
        "gate_w": _w((lambda *s: torch.randn(*s, dtype=torch.bfloat16) * 0.05)(512) * 16.0),
    }

def reference(A_x, A_wqkv, A_w_phi, A_wo, B_x, B_wq, B_wk, B_wv, B_wo, gate_w):
    def _A_ref(x, wqkv, w_phi, wo):
        B, S, D = x.shape
        H = 32; Dh = D // H
        qkv = (lambda x, *d: x.permute(*d))((x @ wqkv).reshape(B, S, 3, H, Dh), 2, 0, 3, 1, 4)
        q, k, v = qkv[0], qkv[1], qkv[2]
        pq = torch.einsum("bhsd,hdf->bhsf", q, w_phi)
        pk = torch.einsum("bhsd,hdf->bhsf", k, w_phi)
        phi_q = torch.concatenate([_softmax(pq, axis=-1), _softmax(-pq, axis=-1)], axis=-1)
        phi_k = torch.concatenate([_softmax(pk, axis=-1), _softmax(-pk, axis=-1)], axis=-1)
        kv = torch.einsum("bhsf,bhsd->bhfd", phi_k, v)
        z  = torch.einsum("bhsf->bhf", phi_k)
        num = torch.einsum("bhqf,bhfd->bhqd", phi_q, kv)
        den = torch.einsum("bhqf,bhf->bhq", phi_q, z)[..., None] + 1e-6
        o = num / den
        return (lambda x, *d: x.permute(*d))(o, 0, 2, 1, 3).reshape(B, S, D) @ wo

    def _B_ref(x, wq, wk, wv, wo):
        B, S, D = x.shape
        H = 32
        Dh = D // H
        q = (lambda x, *d: x.permute(*d))((x @ wq).reshape(B, S, H, Dh), 0, 2, 1, 3)
        k = x @ wk
        v = x @ wv
        scores = torch.einsum("bhqd,bkd->bhqk", q, k) * (Dh ** -0.5)
        p = _softmax(scores, axis=-1)
        o = torch.einsum("bhqk,bkd->bhqd", p, v)
        return (lambda x, *d: x.permute(*d))(o, 0, 2, 1, 3).reshape(B, S, H * Dh) @ wo

    x = A_x
    g = _sigmoid((x * gate_w).sum(-1, keepdims=True))
    a = _A_ref(x, A_wqkv, A_w_phi, A_wo)
    b = _B_ref(x, B_wq, B_wk, B_wv, B_wo)
    return g * a + (1 - g) * b
```

```asm
; @launch grid=(256,1,1) block=(512,1,1) lds=163840
.amdgcn_target "amdgcn-amd-amdhsa--gfx950"
.text
.globl gated_mix__linear_kernel_hedgehog__grouped_kv_mqa__prompt_kernel
.p2align 8
.type gated_mix__linear_kernel_hedgehog__grouped_kv_mqa__prompt_kernel,@function
gated_mix__linear_kernel_hedgehog__grouped_kv_mqa__prompt_kernel:
    s_cmp_ge_u32 s2, 256
    s_cbranch_scc1 L_end
    s_load_dwordx8 s[4:11], s[0:1], 0
    s_load_dwordx8 s[12:19], s[0:1], 32
    s_load_dwordx8 s[20:27], s[0:1], 64
    s_load_dwordx2 s[28:29], s[0:1], 96
    v_readfirstlane_b32 s60, v0
    v_and_b32 v1, 63, v0
    v_and_b32 v2, 31, v0
    v_lshrrev_b32 v3, 5, v1
    v_lshlrev_b32 v4, 4, v1
    s_lshr_b32 s60, s60, 6
    s_and_b32 s61, s60, 3
    s_lshr_b32 s62, s60, 2
    s_lshl_b32 s100, s60, 10
    s_and_b32 s71, s2, 3
    s_lshl_b32 s71, s71, 3
    s_bfe_u32 s72, s2, 0x30003
    s_or_b32 s63, s71, s72
    s_and_b32 s71, s2, 4
    s_lshr_b32 s72, s2, 6
    s_or_b32 s64, s71, s72
    s_lshl_b32 s77, s64, 2
    s_add_u32 s77, s77, s61
    v_and_b32 v6, 15, v1
    v_lshlrev_b32 v6, 10, v6
    v_and_b32 v7, 48, v1
    v_lshl_add_u32 v6, v7, 1, v6
    s_lshl_b32 s71, s63, 16
    s_and_b32 s72, s64, 3
    s_lshl_b32 s72, s72, 14
    s_add_u32 s72, s71, s72
    s_lshl_b32 s73, s60, 7
    s_add_u32 s72, s72, s73
    s_lshl_b32 s74, s60, 11
    s_add_u32 m0, s74, 49152
    s_lshl_b32 s73, s60, 13
    s_add_u32 s97, s71, s73
    s_add_u32 s98, s71, 262144
    s_lshl_b32 s73, s2, 9
    s_lshl_b32 s75, s60, 6
    s_add_u32 s73, s73, s75
    s_add_u32 s73, s73, 131072
    v_mov_b32 v156, 0
    v_mov_b32 v157, 0
    v_mov_b32 v158, 0
    v_mov_b32 v159, 0
    s_cmp_eq_u32 s61, 1
    s_cselect_b32 s76, 1, 3
    s_lshl_b32 s76, s76, 10
    s_lshl_b32 s69, s76, 3
    s_lshl_b32 s70, s76, 6
    s_lshl_b32 s96, s76, 9
    v_lshrrev_b32 v5, 3, v1
    v_mul_lo_u32 v9, v5, s76
    v_lshlrev_b32 v29, 10, v5
    v_bfe_u32 v5, v1, 4, 1
    s_and_b32 s71, s61, 1
    s_lshl_b32 s71, s71, 1
    v_or_b32 v5, s71, v5
    v_lshlrev_b32 v5, 1, v5
    v_and_b32 v8, 7, v1
    v_xor_b32 v5, v5, v8
    v_lshl_add_u32 v9, v5, 4, v9
    s_waitcnt lgkmcnt(0)
    s_mov_b32 s32, s4
    s_mov_b32 s33, s5
    s_mov_b32 s34, 2097152
    s_mov_b32 s35, 0x20000
    buffer_load_dwordx4 v[96:99], v6, s[32:35], s72 offen
    buffer_load_dwordx4 v[100:103], v6, s[32:35], s72 offen offset:16
    s_bitcmp1_b32 s64, 2
    s_cselect_b32 s48, s18, s16
    s_cselect_b32 s49, s19, s17
    s_mov_b32 s50, 16384
    s_mov_b32 s51, 0x20000
    buffer_load_dwordx4 v4, s[48:51], s74 offen lds
    buffer_load_dwordx4 v4, s[48:51], s74 offen offset:1024 lds
    s_mov_b32 s40, s28
    s_mov_b32 s41, s29
    s_mov_b32 s42, 4456448
    s_mov_b32 s43, 0x20000
    s_mov_b64 exec, 15
    buffer_store_dwordx4 v[156:159], v4, s[40:43], s73 offen sc1
    s_mov_b64 exec, -1
    s_max_u32 s71, s61, 1
    s_sub_u32 s71, s71, 1
    s_lshl_b32 s71, s71, 10
    s_lshl_b32 s72, s64, 7
    s_add_u32 s71, s71, s72
    s_mul_i32 s72, s62, s69
    s_lshl_b32 s72, s72, 2
    s_add_u32 s71, s71, s72
    v_add_u32 v9, s71, v9
    s_sub_u32 s69, s69, 1024
    v_lshrrev_b32 v5, 4, v1
    s_and_b32 s72, s60, 1
    s_lshl_b32 s72, s72, 2
    v_or_b32 v5, s72, v5
    v_xor_b32 v5, v5, v8
    v_lshlrev_b32 v242, 4, v5
    v_add_u32 v29, v29, v242
    v_add_u32 v242, 155648, v242
    s_add_u32 s72, s64, s63
    s_and_b32 s84, s72, 7
    s_mov_b32 s101, s84
    s_lshl_b32 s73, s61, 13
    s_lshl_b32 s74, s62, 12
    s_add_u32 s67, s73, s74
    s_cmp_eq_u32 s61, 1
    s_cselect_b32 s36, s14, s6
    s_cselect_b32 s37, s15, s7
    s_mov_b32 s38, s96
    s_mov_b32 s39, 0x20000
    s_cmp_lt_u32 s60, 5
    s_cbranch_scc1 L_nomisc
    s_cmp_eq_u32 s60, 5
    s_cselect_b32 s56, s22, s8
    s_cselect_b32 s57, s23, s9
    s_cselect_b32 s58, 1, 16
    s_lshl_b32 s58, s58, 10
    s_mov_b32 s59, 0x20000
    s_lshl_b32 s73, s64, 11
    s_add_u32 m0, s100, 150528
    s_add_u32 s73, s73, s100
    s_sub_u32 s73, s73, 6144
    s_cmp_eq_u32 s60, 5
    s_cselect_b32 s73, 0, s73
    buffer_load_dwordx4 v4, s[56:59], s73 offen lds
L_nomisc:
    s_cmp_ge_u32 s2, 32
    s_cbranch_scc1 L_nocpf
    s_getpc_b64 s[12:13]
L_pc:
    s_bfe_u32 s73, s2, 0x10003
    s_lshl_b32 s73, s73, 13
    s_add_u32 s73, s73, s100
    s_min_u32 s73, s73, L_codeend-L_pc-1024
    v_add_u32 v14, s73, v4
    global_load_dwordx4 v[248:251], v14, s[12:13]
L_nocpf:
    s_barrier
    s_add_u32 s73, s84, 0
    s_mul_i32 s68, s73, s70
    s_add_u32 m0, s67, 8192
    s_add_u32 s73, s68, s69
    buffer_load_dwordx4 v9, s[36:39], s68 offen lds
    buffer_load_dwordx4 v9, s[36:39], s73 offen offset:1024 lds
    s_add_u32 s73, s73, s69
    buffer_load_dwordx4 v9, s[36:39], s73 offen offset:2048 lds
    s_add_u32 s73, s73, s69
    buffer_load_dwordx4 v9, s[36:39], s73 offen offset:3072 lds
    s_add_u32 m0, s100, 40960
    s_lshl_b32 s73, s84, 7
    s_add_u32 s73, s97, s73
    buffer_load_dwordx4 v29, s[32:35], s73 offen offset:0 lds
    s_add_u32 s84, s84, 1
    s_and_b32 s84, s84, 7
    s_mov_b32 s44, s26
    s_mov_b32 s45, s27
    s_mov_b32 s46, 256
    s_mov_b32 s47, 0x20000
    s_mov_b32 s52, s24
    s_mov_b32 s53, s25
    s_mov_b32 s54, 2097152
    s_mov_b32 s55, 0x20000
    s_mov_b32 s80, 1069066811
    s_mov_b32 s81, 1069066811
    s_mov_b32 s82, 0xffff
    s_mov_b32 s83, 0xffff
    s_cmp_eq_u32 s62, 0
    s_mov_b32 s73, 1052289595
    s_cselect_b32 s78, s73, 1.0
    s_mov_b32 s79, s78
    v_bfe_u32 v5, v1, 1, 3
    v_xor_b32 v5, v5, v3
    v_lshlrev_b32 v5, 4, v5
    v_lshl_add_u32 v5, v2, 7, v5
    v_add_u32 v224, 40960, v5
    v_add_u32 v230, 106496, v5
    v_add_u32 v236, 147456, v5
    v_xor_b32 v7, 32, v5
    v_add_u32 v225, 40960, v7
    v_add_u32 v231, 106496, v7
    v_add_u32 v237, 147456, v7
    v_xor_b32 v7, 64, v5
    v_add_u32 v226, 40960, v7
    v_add_u32 v232, 106496, v7
    v_add_u32 v238, 147456, v7
    v_xor_b32 v7, 96, v5
    v_add_u32 v227, 40960, v7
    v_add_u32 v233, 106496, v7
    v_add_u32 v239, 147456, v7
    v_bfe_u32 v5, v1, 4, 1
    v_bfe_u32 v7, v1, 2, 2
    v_lshlrev_b32 v5, 13, v5
    v_lshl_add_u32 v5, v3, 10, v5
    v_lshl_add_u32 v5, v7, 7, v5
    v_bfe_u32 v7, v1, 3, 2
    v_xor_b32 v7, s61, v7
    v_lshl_add_u32 v5, v7, 5, v5
    v_and_b32 v7, 3, v1
    v_lshl_add_u32 v5, v7, 3, v5
    s_lshl_b32 s73, s62, 14
    v_add_u32 v5, s73, v5
    v_add_u32 v8, s100, v4
    v_add_u32 v228, 8192, v5
    v_add_u32 v229, 40960, v8
    v_add_u32 v234, 73728, v5
    v_add_u32 v235, 106496, v8
    v_add_u32 v240, 114688, v5
    v_add_u32 v241, 147456, v8
    v_and_b32 v5, 15, v1
    v_lshlrev_b32 v5, 3, v5
    v_lshl_add_u32 v6, v3, 7, v5
    v_lshrrev_b32 v7, 4, v1
    v_lshl_add_u32 v5, v7, 9, v5
    s_lshl_b32 s73, s60, 11
    s_add_u32 s73, s73, 49152
    v_add_u32 v7, s73, v5
    s_lshl_b32 s73, s61, 9
    s_add_u32 s73, s73, 156672
    v_add_u32 v6, s73, v6
    s_xor_b32 s73, s63, s64
    s_and_b32 s73, s73, 4
    s_xor_b32 s14, s63, s73
    s_xor_b32 s15, s64, s73
    s_lshl_b32 s16, s14, 16
    s_add_u32 s16, s16, 262144
    s_cmp_eq_u32 s62, 0
    s_cselect_b32 s73, 0, 45056
    s_cselect_b32 s65, 11, 5
    v_add_u32 v27, s73, v4
    v_and_b32 v28, 15, v1
    v_lshlrev_b32 v28, 4, v28
    v_lshl_add_u32 v28, v3, 8, v28
    s_add_u32 s73, s73, 65536
    v_add_u32 v28, s73, v28
    v_mov_b32 v24, 0xdddddddd
    s_mov_b32 s56, s10
    s_mov_b32 s57, s11
    s_mov_b32 s58, 524288
    s_mov_b32 s59, 0x20000
    v_and_b32 v14, 27, v1
    v_cmp_eq_u32 vcc, 16, v14
    v_mov_b32 v14, 158720
    v_mov_b32 v15, 158736
    v_cndmask_b32 v14, v15, v14, vcc
    v_and_b32 v15, 16, v1
    v_cmp_eq_u32 vcc, 0, v15
    v_xor_b32 v244, 16, v15
    v_lshlrev_b32 v244, 8, v244
    v_cndmask_b32 v28, v14, v28, vcc
    v_and_b32 v14, 4, v1
    v_cmp_eq_u32 vcc, 0, v14
    v_mov_b32 v15, 0x3f803f80
    v_lshrrev_b32 v14, 3, v1
    v_cndmask_b32 v15, 0, v15, vcc
    v_lshlrev_b32 v14, 9, v14
    v_and_b32 v12, 7, v1
    v_lshl_add_u32 v14, v12, 2, v14
    v_add_u32 v14, 158720, v14
    ds_write_b32 v14, v15
    ds_write_b32 v14, v15 offset:1024
    v_mov_b64 v[148:149], 0
    v_mov_b64 v[150:151], 0
    v_mov_b64 v[64:65], 0
    v_mov_b64 v[66:67], 0
    v_mov_b64 v[68:69], 0
    v_mov_b64 v[70:71], 0
    v_mov_b64 v[72:73], 0
    v_mov_b64 v[74:75], 0
    v_mov_b64 v[76:77], 0
    v_mov_b64 v[78:79], 0
    v_mov_b64 v[80:81], 0
    v_mov_b64 v[82:83], 0
    v_mov_b64 v[84:85], 0
    v_mov_b64 v[86:87], 0
    v_mov_b64 v[88:89], 0
    v_mov_b64 v[90:91], 0
    v_mov_b64 v[92:93], 0
    v_mov_b64 v[94:95], 0
    s_lshl_b32 s99, s61, 12
    s_add_u32 s99, s99, 131072
    v_lshlrev_b32 v56, 5, v2
    v_lshl_add_u32 v56, v3, 4, v56
    v_add_u32 v56, s99, v56
    v_and_b32 v57, 15, v1
    v_lshlrev_b32 v57, 3, v57
    v_lshl_add_u32 v57, v3, 8, v57
    v_bfe_u32 v14, v1, 4, 1
    v_lshl_add_u32 v57, v14, 10, v57
    v_add_u32 v57, s99, v57
    s_mov_b32 s73, 0x80008000
    v_mul_lo_u32 v61, v14, s73
    s_mul_i32 s73, s61, 2560
    s_add_u32 s73, s73, 148480
    v_add_u32 v58, s73, v4
    v_lshlrev_b32 v59, 3, v1
    v_add_u32 v59, s73, v59
    v_lshlrev_b32 v60, 2, v2
    v_add_u32 v26, 163584, v60
    v_lshl_add_u32 v60, v3, 9, v60
    v_lshrrev_b32 v63, 3, v1
    v_lshlrev_b32 v62, 10, v63
    v_lshlrev_b32 v63, 2, v63
    s_lshl_b32 s73, s60, 5
    s_add_u32 s73, s73, 163584
    v_add_u32 v63, s73, v63
    v_lshlrev_b32 v14, 2, v14
    v_and_b32 v15, 7, v1
    v_xor_b32 v14, v14, v15
    v_lshl_add_u32 v62, v14, 4, v62
    s_lshl_b32 s73, s15, 7
    v_add_u32 v62, s73, v62
    v_bfe_u32 v10, v1, 2, 2
    v_lshlrev_b32 v10, 7, v10
    v_lshl_add_u32 v10, v3, 10, v10
    v_bfe_u32 v14, v1, 3, 1
    v_lshl_add_u32 v10, v14, 6, v10
    v_bfe_u32 v14, v1, 4, 1
    v_lshl_add_u32 v10, v14, 5, v10
    v_bfe_u32 v14, v1, 0, 1
    v_lshl_add_u32 v10, v14, 4, v10
    v_bfe_u32 v14, v1, 1, 1
    v_lshl_add_u32 v10, v14, 3, v10
    s_and_b32 s73, s61, 1
    s_lshl_b32 s73, s73, 14
    s_lshr_b32 s75, s61, 1
    s_lshl_b32 s75, s75, 16
    s_add_u32 s31, s73, s75
    s_cmp_eq_u32 s62, 0
    s_cselect_b32 s73, s99, s31
    v_add_u32 v10, s73, v10
    s_lshl_b32 s73, s61, 5
    v_xor_b32 v10, s73, v10
    v_xor_b32 v11, 64, v10
    v_mov_b32 v12, 163552
    s_waitcnt vmcnt(5)
    ds_read_b64_tr_b16 v[104:105], v7 offset:0
    ds_read_b64_tr_b16 v[106:107], v7 offset:128
    ds_read_b64_tr_b16 v[108:109], v7 offset:256
    ds_read_b64_tr_b16 v[110:111], v7 offset:384
    s_waitcnt lgkmcnt(0)
    s_bitcmp1_b32 s64, 2
    s_cbranch_scc1 L_kv_v
    v_mfma_f32_16x16x32_bf16 v[116:119], v[104:107], v[96:99], 0
    v_mfma_f32_16x16x32_bf16 v[116:119], v[108:111], v[100:103], v[116:119]
    s_branch L_kv_j
L_kv_v:
    v_mfma_f32_16x16x32_bf16 v[116:119], v[96:99], v[104:107], 0
    v_mfma_f32_16x16x32_bf16 v[116:119], v[100:103], v[108:111], v[116:119]
L_kv_j:
    ds_write_b128 v12, v[156:159]
    ds_write_b128 v12, v[156:159] offset:16
    s_nop 5
    ds_write_b128 v8, v[116:119] offset:0
    s_waitcnt lgkmcnt(0)
    s_barrier
    s_cmp_lg_u32 s60, 0
    s_cbranch_scc1 L_nokv
    ds_read_b128 v[192:195], v4 offset:0
    ds_read_b128 v[196:199], v4 offset:1024
    ds_read_b128 v[200:203], v4 offset:2048
    ds_read_b128 v[204:207], v4 offset:3072
    ds_read_b128 v[208:211], v4 offset:4096
    ds_read_b128 v[212:215], v4 offset:5120
    ds_read_b128 v[216:219], v4 offset:6144
    ds_read_b128 v[220:223], v4 offset:7168
    s_and_b32 s72, s64, 3
    s_bitcmp1_b32 s64, 2
    s_cbranch_scc1 L_kva_v
    v_and_b32 v5, 15, v1
    v_lshlrev_b32 v5, 4, v5
    v_bfe_u32 v7, v1, 4, 1
    v_lshl_add_u32 v5, v7, 9, v5
    v_lshl_add_u32 v5, v3, 3, v5
    s_lshl_b32 s73, s63, 11
    s_lshr_b32 s75, s72, 1
    s_lshl_b32 s75, s75, 10
    s_add_u32 s73, s73, s75
    s_and_b32 s75, s72, 1
    s_lshl_b32 s75, s75, 8
    s_add_u32 s73, s73, s75
    s_branch L_kva_j
L_kva_v:
    v_and_b32 v5, 3, v1
    v_lshlrev_b32 v5, 4, v5
    v_bfe_u32 v7, v1, 2, 1
    v_lshl_add_u32 v5, v7, 7, v5
    v_bfe_u32 v7, v1, 3, 1
    v_lshl_add_u32 v5, v7, 6, v5
    v_bfe_u32 v7, v1, 4, 1
    v_lshl_add_u32 v5, v7, 3, v5
    v_lshl_add_u32 v5, v3, 8, v5
    s_lshl_b32 s73, s63, 11
    s_lshl_b32 s75, s72, 9
    s_add_u32 s73, s73, s75
    s_add_u32 s73, s73, 65536
L_kva_j:
    s_waitcnt lgkmcnt(0)
    v_pk_add_f32 v[192:193], v[192:193], v[208:209]
    v_pk_add_f32 v[194:195], v[194:195], v[210:211]
    v_pk_add_f32 v[196:197], v[196:197], v[212:213]
    v_pk_add_f32 v[198:199], v[198:199], v[214:215]
    v_pk_add_f32 v[200:201], v[200:201], v[216:217]
    v_pk_add_f32 v[202:203], v[202:203], v[218:219]
    v_pk_add_f32 v[204:205], v[204:205], v[220:221]
    v_pk_add_f32 v[206:207], v[206:207], v[222:223]
    v_pk_add_f32 v[192:193], v[192:193], v[200:201]
    v_pk_add_f32 v[194:195], v[194:195], v[202:203]
    v_pk_add_f32 v[196:197], v[196:197], v[204:205]
    v_pk_add_f32 v[198:199], v[198:199], v[206:207]
    v_pk_add_f32 v[192:193], v[192:193], v[196:197]
    v_pk_add_f32 v[194:195], v[194:195], v[198:199]
    s_bitcmp1_b32 s64, 2
    s_cselect_b32 s75, 1317011456, 1.0
    v_mul_f32 v192, s75, v192
    v_mul_f32 v193, s75, v193
    v_mul_f32 v194, s75, v194
    v_mul_f32 v195, s75, v195
    v_cvt_pk_bf16_f32 v192, v192, v193
    v_cvt_pk_bf16_f32 v193, v194, v195
    buffer_store_dwordx2 v[192:193], v5, s[40:43], s73 offen sc1
L_nokv:
    s_add_u32 s73, s84, 0
    s_mul_i32 s68, s73, s70
    s_add_u32 m0, s67, 73728
    s_add_u32 s73, s68, s69
    buffer_load_dwordx4 v9, s[36:39], s68 offen lds
    buffer_load_dwordx4 v9, s[36:39], s73 offen offset:1024 lds
    s_add_u32 s73, s73, s69
    buffer_load_dwordx4 v9, s[36:39], s73 offen offset:2048 lds
    s_add_u32 s73, s73, s69
    buffer_load_dwordx4 v9, s[36:39], s73 offen offset:3072 lds
    s_add_u32 m0, s100, 106496
    s_lshl_b32 s73, s84, 7
    s_add_u32 s73, s97, s73
    buffer_load_dwordx4 v29, s[32:35], s73 offen offset:0 lds
    s_add_u32 s84, s84, 1
    s_and_b32 s84, s84, 7
    v_and_b32 v13, 7, v1
    v_lshlrev_b32 v13, 5, v13
    v_mov_b32 v12, 1
    s_lshl_b32 s73, s101, 7
    v_add_u32 v243, s73, v242
    s_waitcnt vmcnt(6)
    s_cmp_eq_u32 s60, 0
    s_cbranch_scc1 L_w0a
    s_waitcnt vmcnt(5)
L_w0a:
    s_barrier
    ds_read_b64_tr_b16 v[152:153], v6
    ds_read_b64_tr_b16 v[154:155], v6 offset:256
    s_cmp_eq_u32 s62, 0
    s_cbranch_scc1 L_pp
    s_setprio 1
L_pp:
    ds_read_b64_tr_b16 v[32:33], v228 offset:0
    ds_read_b64_tr_b16 v[34:35], v228 offset:512
    ds_read_b128 v[40:43], v224 offset:0
    ds_read_b128 v[48:51], v224 offset:4096
    ds_read_b64_tr_b16 v[36:37], v228 offset:2048
    ds_read_b64_tr_b16 v[38:39], v228 offset:2560
    ds_read_b128 v[44:47], v225 offset:0
    ds_read_b128 v[52:55], v225 offset:4096
    ds_read_b128 v[120:123], v229
    ds_read_b128 v[124:127], v243 offset:0
    s_add_u32 s73, s84, 0
    s_mul_i32 s68, s73, s70
    s_add_u32 m0, s67, 114688
    s_add_u32 s73, s68, s69
    buffer_load_dwordx4 v9, s[36:39], s68 offen lds
    buffer_load_dwordx4 v9, s[36:39], s73 offen offset:1024 lds
    s_add_u32 s73, s73, s69
    s_add_u32 s101, s101, 1
    s_and_b32 s101, s101, 7
    s_lshl_b32 s74, s101, 7
    v_add_u32 v243, s74, v242
    buffer_load_dwordx4 v9, s[36:39], s73 offen offset:2048 lds
    s_add_u32 s73, s73, s69
    s_waitcnt lgkmcnt(0)
    v_dot2_f32_bf16 v156, v120, v124, v156
    v_dot2_f32_bf16 v157, v121, v125, v157
    v_dot2_f32_bf16 v158, v122, v126, v158
    v_dot2_f32_bf16 v159, v123, v127, v159
    v_mfma_f32_32x32x16_bf16 v[160:175], v[32:35], v[40:43], 0
    ds_read_b64_tr_b16 v[96:97], v228 offset:4096
    ds_read_b64_tr_b16 v[98:99], v228 offset:4608
    ds_read_b128 v[104:107], v226 offset:0
    ds_read_b128 v[112:115], v226 offset:4096
    v_mfma_f32_32x32x16_bf16 v[176:191], v[32:35], v[48:51], 0
    ds_read_b64_tr_b16 v[100:101], v228 offset:6144
    ds_read_b64_tr_b16 v[102:103], v228 offset:6656
    ds_read_b128 v[108:111], v227 offset:0
    ds_read_b128 v[116:119], v227 offset:4096
    buffer_load_dwordx4 v9, s[36:39], s73 offen offset:3072 lds
    v_mfma_f32_32x32x16_bf16 v[160:175], v[36:39], v[44:47], v[160:175]
    s_add_u32 m0, s100, 147456
    s_lshl_b32 s73, s84, 7
    s_add_u32 s73, s97, s73
    buffer_load_dwordx4 v29, s[32:35], s73 offen offset:0 lds
    s_add_u32 s84, s84, 1
    s_and_b32 s84, s84, 7
    v_mfma_f32_32x32x16_bf16 v[176:191], v[36:39], v[52:55], v[176:191]
    s_waitcnt vmcnt(5) lgkmcnt(0)
    s_cmp_lg_u32 s60, 0
    s_cbranch_scc1 L_noarr
    s_and_b32 s73, s2, 7
    s_lshl_b32 s73, s73, 5
    s_mov_b64 exec, 1
    buffer_atomic_add v12, v13, s[44:47], s73 offen sc1
    s_mov_b64 exec, -1
L_noarr:
    s_barrier
    v_mfma_f32_32x32x16_bf16 v[160:175], v[96:99], v[104:107], v[160:175]
    ds_read_b64_tr_b16 v[32:33], v234 offset:0
    ds_read_b64_tr_b16 v[34:35], v234 offset:512
    ds_read_b128 v[40:43], v230 offset:0
    ds_read_b128 v[48:51], v230 offset:4096
    v_mfma_f32_32x32x16_bf16 v[176:191], v[96:99], v[112:115], v[176:191]
    ds_read_b64_tr_b16 v[36:37], v234 offset:2048
    ds_read_b64_tr_b16 v[38:39], v234 offset:2560
    ds_read_b128 v[44:47], v231 offset:0
    ds_read_b128 v[52:55], v231 offset:4096
    ds_read_b128 v[120:123], v235
    ds_read_b128 v[124:127], v243 offset:0
    s_add_u32 s73, s84, 0
    s_mul_i32 s68, s73, s70
    s_add_u32 m0, s67, 8192
    s_add_u32 s73, s68, s69
    buffer_load_dwordx4 v9, s[36:39], s68 offen lds
    v_mfma_f32_32x32x16_bf16 v[160:175], v[100:103], v[108:111], v[160:175]
    buffer_load_dwordx4 v9, s[36:39], s73 offen offset:1024 lds
    s_add_u32 s73, s73, s69
    s_add_u32 s101, s101, 1
    s_and_b32 s101, s101, 7
    s_lshl_b32 s74, s101, 7
    v_add_u32 v243, s74, v242
    v_xor_b32 v152, v61, v152
    v_xor_b32 v153, v61, v153
    v_xor_b32 v154, v61, v154
    v_xor_b32 v155, v61, v155
    buffer_load_dwordx4 v9, s[36:39], s73 offen offset:2048 lds
    s_add_u32 s73, s73, s69
    v_mfma_f32_32x32x16_bf16 v[176:191], v[100:103], v[116:119], v[176:191]
    s_waitcnt lgkmcnt(0)
    v_dot2_f32_bf16 v156, v120, v124, v156
    v_dot2_f32_bf16 v157, v121, v125, v157
    v_dot2_f32_bf16 v158, v122, v126, v158
    v_dot2_f32_bf16 v159, v123, v127, v159
    v_mfma_f32_32x32x16_bf16 v[160:175], v[32:35], v[40:43], v[160:175]
    ds_read_b64_tr_b16 v[96:97], v234 offset:4096
    ds_read_b64_tr_b16 v[98:99], v234 offset:4608
    ds_read_b128 v[104:107], v232 offset:0
    ds_read_b128 v[112:115], v232 offset:4096
    v_mfma_f32_32x32x16_bf16 v[176:191], v[32:35], v[48:51], v[176:191]
    ds_read_b64_tr_b16 v[100:101], v234 offset:6144
    ds_read_b64_tr_b16 v[102:103], v234 offset:6656
    ds_read_b128 v[108:111], v233 offset:0
    ds_read_b128 v[116:119], v233 offset:4096
    buffer_load_dwordx4 v9, s[36:39], s73 offen offset:3072 lds
    v_mfma_f32_32x32x16_bf16 v[160:175], v[36:39], v[44:47], v[160:175]
    s_add_u32 m0, s100, 40960
    s_lshl_b32 s73, s84, 7
    s_add_u32 s73, s97, s73
    buffer_load_dwordx4 v29, s[32:35], s73 offen offset:0 lds
    s_add_u32 s84, s84, 1
    s_and_b32 s84, s84, 7
    v_mfma_f32_32x32x16_bf16 v[176:191], v[36:39], v[52:55], v[176:191]
    s_waitcnt vmcnt(6) lgkmcnt(0)
    s_cmp_eq_u32 s60, 0
    s_cbranch_scc1 L_w0b
    s_waitcnt vmcnt(5)
L_w0b:
    s_barrier
    v_mfma_f32_32x32x16_bf16 v[160:175], v[96:99], v[104:107], v[160:175]
    ds_read_b64_tr_b16 v[32:33], v240 offset:0
    ds_read_b64_tr_b16 v[34:35], v240 offset:512
    ds_read_b128 v[40:43], v236 offset:0
    ds_read_b128 v[48:51], v236 offset:4096
    v_mfma_f32_32x32x16_bf16 v[176:191], v[96:99], v[112:115], v[176:191]
    ds_read_b64_tr_b16 v[36:37], v240 offset:2048
    ds_read_b64_tr_b16 v[38:39], v240 offset:2560
    ds_read_b128 v[44:47], v237 offset:0
    ds_read_b128 v[52:55], v237 offset:4096
    ds_read_b128 v[120:123], v241
    ds_read_b128 v[124:127], v243 offset:0
    s_add_u32 s73, s84, 0
    s_mul_i32 s68, s73, s70
    s_add_u32 m0, s67, 73728
    s_add_u32 s73, s68, s69
    buffer_load_dwordx4 v9, s[36:39], s68 offen lds
    v_mfma_f32_32x32x16_bf16 v[160:175], v[100:103], v[108:111], v[160:175]
    buffer_load_dwordx4 v9, s[36:39], s73 offen offset:1024 lds
    s_add_u32 s73, s73, s69
    s_add_u32 s101, s101, 1
    s_and_b32 s101, s101, 7
    s_lshl_b32 s74, s101, 7
    v_add_u32 v243, s74, v242
    buffer_load_dwordx4 v9, s[36:39], s73 offen offset:2048 lds
    s_add_u32 s73, s73, s69
    v_mfma_f32_32x32x16_bf16 v[176:191], v[100:103], v[116:119], v[176:191]
    s_waitcnt lgkmcnt(0)
    v_dot2_f32_bf16 v156, v120, v124, v156
    v_dot2_f32_bf16 v157, v121, v125, v157
    v_dot2_f32_bf16 v158, v122, v126, v158
    v_dot2_f32_bf16 v159, v123, v127, v159
    v_mfma_f32_32x32x16_bf16 v[160:175], v[32:35], v[40:43], v[160:175]
    ds_read_b64_tr_b16 v[96:97], v240 offset:4096
    ds_read_b64_tr_b16 v[98:99], v240 offset:4608
    ds_read_b128 v[104:107], v238 offset:0
    ds_read_b128 v[112:115], v238 offset:4096
    v_mfma_f32_32x32x16_bf16 v[176:191], v[32:35], v[48:51], v[176:191]
    ds_read_b64_tr_b16 v[100:101], v240 offset:6144
    ds_read_b64_tr_b16 v[102:103], v240 offset:6656
    ds_read_b128 v[108:111], v239 offset:0
    ds_read_b128 v[116:119], v239 offset:4096
    buffer_load_dwordx4 v9, s[36:39], s73 offen offset:3072 lds
    v_mfma_f32_32x32x16_bf16 v[160:175], v[36:39], v[44:47], v[160:175]
    s_add_u32 m0, s100, 106496
    s_lshl_b32 s73, s84, 7
    s_add_u32 s73, s97, s73
    buffer_load_dwordx4 v29, s[32:35], s73 offen offset:0 lds
    s_add_u32 s84, s84, 1
    s_and_b32 s84, s84, 7
    v_mfma_f32_32x32x16_bf16 v[176:191], v[36:39], v[52:55], v[176:191]
    s_waitcnt vmcnt(5) lgkmcnt(0)
    s_barrier
    v_mfma_f32_32x32x16_bf16 v[160:175], v[96:99], v[104:107], v[160:175]
    ds_read_b64_tr_b16 v[32:33], v228 offset:0
    ds_read_b64_tr_b16 v[34:35], v228 offset:512
    ds_read_b128 v[40:43], v224 offset:0
    ds_read_b128 v[48:51], v224 offset:4096
    v_mfma_f32_32x32x16_bf16 v[176:191], v[96:99], v[112:115], v[176:191]
    ds_read_b64_tr_b16 v[36:37], v228 offset:2048
    ds_read_b64_tr_b16 v[38:39], v228 offset:2560
    ds_read_b128 v[44:47], v225 offset:0
    ds_read_b128 v[52:55], v225 offset:4096
    ds_read_b128 v[120:123], v229
    ds_read_b128 v[124:127], v243 offset:0
    s_add_u32 s73, s84, 0
    s_mul_i32 s68, s73, s70
    s_add_u32 m0, s67, 114688
    s_add_u32 s73, s68, s69
    buffer_load_dwordx4 v9, s[36:39], s68 offen lds
    v_mfma_f32_32x32x16_bf16 v[160:175], v[100:103], v[108:111], v[160:175]
    buffer_load_dwordx4 v9, s[36:39], s73 offen offset:1024 lds
    s_add_u32 s73, s73, s69
    s_add_u32 s101, s101, 1
    s_and_b32 s101, s101, 7
    s_lshl_b32 s74, s101, 7
    v_add_u32 v243, s74, v242
    buffer_load_dwordx4 v9, s[36:39], s73 offen offset:2048 lds
    s_add_u32 s73, s73, s69
    v_mfma_f32_32x32x16_bf16 v[176:191], v[100:103], v[116:119], v[176:191]
    s_waitcnt lgkmcnt(0)
    v_dot2_f32_bf16 v156, v120, v124, v156
    v_dot2_f32_bf16 v157, v121, v125, v157
    v_dot2_f32_bf16 v158, v122, v126, v158
    v_dot2_f32_bf16 v159, v123, v127, v159
    v_mfma_f32_32x32x16_bf16 v[160:175], v[32:35], v[40:43], v[160:175]
    ds_read_b64_tr_b16 v[96:97], v228 offset:4096
    ds_read_b64_tr_b16 v[98:99], v228 offset:4608
    ds_read_b128 v[104:107], v226 offset:0
    ds_read_b128 v[112:115], v226 offset:4096
    v_mfma_f32_32x32x16_bf16 v[176:191], v[32:35], v[48:51], v[176:191]
    ds_read_b64_tr_b16 v[100:101], v228 offset:6144
    ds_read_b64_tr_b16 v[102:103], v228 offset:6656
    ds_read_b128 v[108:111], v227 offset:0
    ds_read_b128 v[116:119], v227 offset:4096
    buffer_load_dwordx4 v9, s[36:39], s73 offen offset:3072 lds
    v_mfma_f32_32x32x16_bf16 v[160:175], v[36:39], v[44:47], v[160:175]
    s_add_u32 m0, s100, 147456
    s_lshl_b32 s73, s84, 7
    s_add_u32 s73, s97, s73
    buffer_load_dwordx4 v29, s[32:35], s73 offen offset:0 lds
    s_add_u32 s84, s84, 1
    s_and_b32 s84, s84, 7
    v_mfma_f32_32x32x16_bf16 v[176:191], v[36:39], v[52:55], v[176:191]
    s_waitcnt vmcnt(5) lgkmcnt(0)
    s_barrier
    v_mfma_f32_32x32x16_bf16 v[160:175], v[96:99], v[104:107], v[160:175]
    ds_read_b64_tr_b16 v[32:33], v234 offset:0
    ds_read_b64_tr_b16 v[34:35], v234 offset:512
    ds_read_b128 v[40:43], v230 offset:0
    ds_read_b128 v[48:51], v230 offset:4096
    v_mfma_f32_32x32x16_bf16 v[176:191], v[96:99], v[112:115], v[176:191]
    ds_read_b64_tr_b16 v[36:37], v234 offset:2048
    ds_read_b64_tr_b16 v[38:39], v234 offset:2560
    ds_read_b128 v[44:47], v231 offset:0
    ds_read_b128 v[52:55], v231 offset:4096
    ds_read_b128 v[120:123], v235
    ds_read_b128 v[124:127], v243 offset:0
    s_add_u32 s73, s84, 0
    s_mul_i32 s68, s73, s70
    s_add_u32 m0, s67, 8192
    s_add_u32 s73, s68, s69
    buffer_load_dwordx4 v9, s[36:39], s68 offen lds
    v_mfma_f32_32x32x16_bf16 v[160:175], v[100:103], v[108:111], v[160:175]
    buffer_load_dwordx4 v9, s[36:39], s73 offen offset:1024 lds
    s_add_u32 s73, s73, s69
    s_add_u32 s101, s101, 1
    s_and_b32 s101, s101, 7
    s_lshl_b32 s74, s101, 7
    v_add_u32 v243, s74, v242
    buffer_load_dwordx4 v9, s[36:39], s73 offen offset:2048 lds
    s_add_u32 s73, s73, s69
    v_mfma_f32_32x32x16_bf16 v[176:191], v[100:103], v[116:119], v[176:191]
    s_waitcnt lgkmcnt(0)
    v_dot2_f32_bf16 v156, v120, v124, v156
    v_dot2_f32_bf16 v157, v121, v125, v157
    v_dot2_f32_bf16 v158, v122, v126, v158
    v_dot2_f32_bf16 v159, v123, v127, v159
    v_mfma_f32_32x32x16_bf16 v[160:175], v[32:35], v[40:43], v[160:175]
    ds_read_b64_tr_b16 v[96:97], v234 offset:4096
    ds_read_b64_tr_b16 v[98:99], v234 offset:4608
    ds_read_b128 v[104:107], v232 offset:0
    ds_read_b128 v[112:115], v232 offset:4096
    v_mfma_f32_32x32x16_bf16 v[176:191], v[32:35], v[48:51], v[176:191]
    ds_read_b64_tr_b16 v[100:101], v234 offset:6144
    ds_read_b64_tr_b16 v[102:103], v234 offset:6656
    ds_read_b128 v[108:111], v233 offset:0
    ds_read_b128 v[116:119], v233 offset:4096
    buffer_load_dwordx4 v9, s[36:39], s73 offen offset:3072 lds
    v_mfma_f32_32x32x16_bf16 v[160:175], v[36:39], v[44:47], v[160:175]
    s_add_u32 m0, s100, 40960
    s_lshl_b32 s73, s84, 7
    s_add_u32 s73, s97, s73
    buffer_load_dwordx4 v29, s[32:35], s73 offen offset:0 lds
    s_add_u32 s84, s84, 1
    s_and_b32 s84, s84, 7
    v_mfma_f32_32x32x16_bf16 v[176:191], v[36:39], v[52:55], v[176:191]
    s_waitcnt vmcnt(5) lgkmcnt(0)
    s_cmp_lg_u32 s60, 0
    s_cbranch_scc1 L_d1a
    buffer_load_dword v12, v13, s[44:47], 0 offen sc1
L_d1a:
    s_barrier
    v_mfma_f32_32x32x16_bf16 v[160:175], v[96:99], v[104:107], v[160:175]
    ds_read_b64_tr_b16 v[32:33], v240 offset:0
    ds_read_b64_tr_b16 v[34:35], v240 offset:512
    ds_read_b128 v[40:43], v236 offset:0
    ds_read_b128 v[48:51], v236 offset:4096
    v_mfma_f32_32x32x16_bf16 v[176:191], v[96:99], v[112:115], v[176:191]
    ds_read_b64_tr_b16 v[36:37], v240 offset:2048
    ds_read_b64_tr_b16 v[38:39], v240 offset:2560
    ds_read_b128 v[44:47], v237 offset:0
    ds_read_b128 v[52:55], v237 offset:4096
    ds_read_b128 v[120:123], v241
    ds_read_b128 v[124:127], v243 offset:0
    s_add_u32 s73, s84, 0
    s_mul_i32 s68, s73, s70
    s_add_u32 m0, s67, 73728
    s_add_u32 s73, s68, s69
    buffer_load_dwordx4 v9, s[36:39], s68 offen lds
    v_mfma_f32_32x32x16_bf16 v[160:175], v[100:103], v[108:111], v[160:175]
    buffer_load_dwordx4 v9, s[36:39], s73 offen offset:1024 lds
    s_add_u32 s73, s73, s69
    s_add_u32 s101, s101, 1
    s_and_b32 s101, s101, 7
    s_lshl_b32 s74, s101, 7
    v_add_u32 v243, s74, v242
    buffer_load_dwordx4 v9, s[36:39], s73 offen offset:2048 lds
    s_add_u32 s73, s73, s69
    v_mfma_f32_32x32x16_bf16 v[176:191], v[100:103], v[116:119], v[176:191]
    s_waitcnt lgkmcnt(0)
    v_dot2_f32_bf16 v156, v120, v124, v156
    v_dot2_f32_bf16 v157, v121, v125, v157
    v_dot2_f32_bf16 v158, v122, v126, v158
    v_dot2_f32_bf16 v159, v123, v127, v159
    v_mfma_f32_32x32x16_bf16 v[160:175], v[32:35], v[40:43], v[160:175]
    ds_read_b64_tr_b16 v[96:97], v240 offset:4096
    ds_read_b64_tr_b16 v[98:99], v240 offset:4608
    ds_read_b128 v[104:107], v238 offset:0
    ds_read_b128 v[112:115], v238 offset:4096
    v_mfma_f32_32x32x16_bf16 v[176:191], v[32:35], v[48:51], v[176:191]
    ds_read_b64_tr_b16 v[100:101], v240 offset:6144
    ds_read_b64_tr_b16 v[102:103], v240 offset:6656
    ds_read_b128 v[108:111], v239 offset:0
    ds_read_b128 v[116:119], v239 offset:4096
    buffer_load_dwordx4 v9, s[36:39], s73 offen offset:3072 lds
    v_mfma_f32_32x32x16_bf16 v[160:175], v[36:39], v[44:47], v[160:175]
    s_add_u32 m0, s100, 106496
    s_lshl_b32 s73, s84, 7
    s_add_u32 s73, s97, s73
    buffer_load_dwordx4 v29, s[32:35], s73 offen offset:0 lds
    s_add_u32 s84, s84, 1
    s_and_b32 s84, s84, 7
    v_mfma_f32_32x32x16_bf16 v[176:191], v[36:39], v[52:55], v[176:191]
    s_waitcnt vmcnt(5) lgkmcnt(0)
    s_cmp_lg_u32 s60, 0
    s_cbranch_scc1 L_d1done
    s_mov_b32 s85, 0x40000
L_d1poll:
    v_cmp_gt_u32 vcc, 32, v12
    s_sub_u32 s85, s85, 1
    s_cbranch_scc1 L_d1done
    s_cbranch_vccz L_d1done
    s_sleep 6
    buffer_load_dword v12, v13, s[44:47], 0 offen sc1
    s_waitcnt vmcnt(0)
    s_branch L_d1poll
L_d1done:
    s_barrier
    v_mfma_f32_32x32x16_bf16 v[160:175], v[96:99], v[104:107], v[160:175]
    ds_read_b64_tr_b16 v[32:33], v228 offset:0
    ds_read_b64_tr_b16 v[34:35], v228 offset:512
    ds_read_b128 v[40:43], v224 offset:0
    ds_read_b128 v[48:51], v224 offset:4096
    v_mfma_f32_32x32x16_bf16 v[176:191], v[96:99], v[112:115], v[176:191]
    ds_read_b64_tr_b16 v[36:37], v228 offset:2048
    ds_read_b64_tr_b16 v[38:39], v228 offset:2560
    ds_read_b128 v[44:47], v225 offset:0
    ds_read_b128 v[52:55], v225 offset:4096
    ds_read_b128 v[120:123], v229
    ds_read_b128 v[124:127], v243 offset:0
    s_add_u32 s73, s100, 0
    s_mov_b32 m0, s73
    s_nop 0
    buffer_load_dwordx4 v4, s[40:43], s73 offen sc1 lds
    v_mfma_f32_32x32x16_bf16 v[160:175], v[100:103], v[108:111], v[160:175]
    s_add_u32 s73, s100, 65536
    s_mov_b32 m0, s73
    s_nop 0
    buffer_load_dwordx4 v4, s[40:43], s73 offen sc1 lds
    s_add_u32 s101, s101, 1
    s_and_b32 s101, s101, 7
    s_lshl_b32 s74, s101, 7
    v_add_u32 v243, s74, v242
    s_add_u32 s73, s100, 49152
    s_mov_b32 m0, s73
    s_nop 0
    buffer_load_dwordx4 v4, s[40:43], s73 offen sc1 lds
    v_mfma_f32_32x32x16_bf16 v[176:191], v[100:103], v[116:119], v[176:191]
    s_waitcnt lgkmcnt(0)
    v_dot2_f32_bf16 v156, v120, v124, v156
    v_dot2_f32_bf16 v157, v121, v125, v157
    v_dot2_f32_bf16 v158, v122, v126, v158
    v_dot2_f32_bf16 v159, v123, v127, v159
    v_mfma_f32_32x32x16_bf16 v[160:175], v[32:35], v[40:43], v[160:175]
    ds_read_b64_tr_b16 v[96:97], v228 offset:4096
    ds_read_b64_tr_b16 v[98:99], v228 offset:4608
    ds_read_b128 v[104:107], v226 offset:0
    ds_read_b128 v[112:115], v226 offset:4096
    v_mfma_f32_32x32x16_bf16 v[176:191], v[32:35], v[48:51], v[176:191]
    ds_read_b64_tr_b16 v[100:101], v228 offset:6144
    ds_read_b64_tr_b16 v[102:103], v228 offset:6656
    ds_read_b128 v[108:111], v227 offset:0
    ds_read_b128 v[116:119], v227 offset:4096
    s_add_u32 s73, s100, 57344
    s_mov_b32 m0, s73
    s_nop 0
    buffer_load_dwordx4 v4, s[40:43], s73 offen sc1 lds
    v_mfma_f32_32x32x16_bf16 v[160:175], v[36:39], v[44:47], v[160:175]
    s_add_u32 s73, s100, 114688
    s_mov_b32 m0, s73
    s_nop 0
    buffer_load_dwordx4 v4, s[40:43], s73 offen sc1 lds
    s_add_u32 s73, s100, 122880
    s_mov_b32 m0, s73
    s_nop 0
    buffer_load_dwordx4 v4, s[40:43], s73 offen sc1 lds
    v_mfma_f32_32x32x16_bf16 v[176:191], v[36:39], v[52:55], v[176:191]
    s_waitcnt vmcnt(6) lgkmcnt(0)
    s_barrier
    v_mfma_f32_32x32x16_bf16 v[160:175], v[96:99], v[104:107], v[160:175]
    ds_read_b64_tr_b16 v[32:33], v234 offset:0
    ds_read_b64_tr_b16 v[34:35], v234 offset:512
    ds_read_b128 v[40:43], v230 offset:0
    ds_read_b128 v[48:51], v230 offset:4096
    v_mfma_f32_32x32x16_bf16 v[176:191], v[96:99], v[112:115], v[176:191]
    ds_read_b64_tr_b16 v[36:37], v234 offset:2048
    ds_read_b64_tr_b16 v[38:39], v234 offset:2560
    ds_read_b128 v[44:47], v231 offset:0
    ds_read_b128 v[52:55], v231 offset:4096
    ds_read_b128 v[120:123], v235
    ds_read_b128 v[124:127], v243 offset:0
    s_add_u32 s73, s100, 8192
    s_mov_b32 m0, s73
    s_nop 0
    buffer_load_dwordx4 v4, s[40:43], s73 offen sc1 lds
    v_mfma_f32_32x32x16_bf16 v[160:175], v[100:103], v[108:111], v[160:175]
    s_add_u32 s73, s100, 16384
    s_mov_b32 m0, s73
    s_nop 0
    buffer_load_dwordx4 v4, s[40:43], s73 offen sc1 lds
    s_add_u32 s101, s101, 1
    s_and_b32 s101, s101, 7
    s_lshl_b32 s74, s101, 7
    v_add_u32 v243, s74, v242
    s_add_u32 s73, s100, 24576
    s_mov_b32 m0, s73
    s_nop 0
    buffer_load_dwordx4 v4, s[40:43], s73 offen sc1 lds
    v_mfma_f32_32x32x16_bf16 v[176:191], v[100:103], v[116:119], v[176:191]
    s_waitcnt lgkmcnt(0)
    v_dot2_f32_bf16 v156, v120, v124, v156
    v_dot2_f32_bf16 v157, v121, v125, v157
    v_dot2_f32_bf16 v158, v122, v126, v158
    v_dot2_f32_bf16 v159, v123, v127, v159
    v_mfma_f32_32x32x16_bf16 v[160:175], v[32:35], v[40:43], v[160:175]
    ds_read_b64_tr_b16 v[96:97], v234 offset:4096
    ds_read_b64_tr_b16 v[98:99], v234 offset:4608
    ds_read_b128 v[104:107], v232 offset:0
    ds_read_b128 v[112:115], v232 offset:4096
    v_mfma_f32_32x32x16_bf16 v[176:191], v[32:35], v[48:51], v[176:191]
    ds_read_b64_tr_b16 v[100:101], v234 offset:6144
    ds_read_b64_tr_b16 v[102:103], v234 offset:6656
    ds_read_b128 v[108:111], v233 offset:0
    ds_read_b128 v[116:119], v233 offset:4096
    s_add_u32 s73, s100, 32768
    s_mov_b32 m0, s73
    s_nop 0
    buffer_load_dwordx4 v4, s[40:43], s73 offen sc1 lds
    v_mfma_f32_32x32x16_bf16 v[160:175], v[36:39], v[44:47], v[160:175]
    s_add_u32 s73, s100, 40960
    s_mov_b32 m0, s73
    s_nop 0
    buffer_load_dwordx4 v4, s[40:43], s73 offen sc1 lds
    v_mfma_f32_32x32x16_bf16 v[176:191], v[36:39], v[52:55], v[176:191]
    s_waitcnt vmcnt(9) lgkmcnt(0)
    s_barrier
    ds_read_b128 v[128:131], v4
    v_mfma_f32_32x32x16_bf16 v[160:175], v[96:99], v[104:107], v[160:175]
    v_mfma_f32_32x32x16_bf16 v[176:191], v[96:99], v[112:115], v[176:191]
    v_mfma_f32_32x32x16_bf16 v[160:175], v[100:103], v[108:111], v[160:175]
    v_mfma_f32_32x32x16_bf16 v[176:191], v[100:103], v[116:119], v[176:191]
    v_add_f32 v156, v156, v157
    v_add_f32 v158, v158, v159
    v_mov_b32 v9, v62
    v_add_f32 v156, v156, v158
    s_nop 1
    v_add_f32_dpp v156, v156, v156 quad_perm:[1,0,3,2] row_mask:0xf bank_mask:0xf
    s_nop 1
    v_add_f32_dpp v156, v156, v156 quad_perm:[2,3,0,1] row_mask:0xf bank_mask:0xf
    s_nop 1
    v_add_f32_dpp v156, v156, v156 row_half_mirror row_mask:0xf bank_mask:0xf
    v_mul_f32 v156, s80, v156
    v_exp_f32 v156, -v156
    s_nop 0
    v_add_f32 v156, 1.0, v156
    v_rcp_f32 v156, v156
    s_nop 0
    ds_write_b32 v63, v156
    v_mov_b32 v29, v244
    s_cmp_lg_u32 s62, 0
    s_cbranch_scc1 L_role1
    v_pk_mul_f32 v[168:169], v[168:169], s[78:79]
    v_pk_mul_f32 v[170:171], v[170:171], s[78:79]
    v_pk_mul_f32 v[172:173], v[172:173], s[78:79]
    v_pk_mul_f32 v[174:175], v[174:175], s[78:79]
    v_pk_mul_f32 v[184:185], v[184:185], s[78:79]
    v_pk_mul_f32 v[186:187], v[186:187], s[78:79]
    v_pk_mul_f32 v[188:189], v[188:189], s[78:79]
    v_pk_mul_f32 v[190:191], v[190:191], s[78:79]
    v_cvt_pk_bf16_f32 v16, v168, v169
    v_cvt_pk_bf16_f32 v17, v170, v171
    v_cvt_pk_bf16_f32 v18, v172, v173
    v_cvt_pk_bf16_f32 v19, v174, v175
    v_cvt_pk_bf16_f32 v20, v184, v185
    v_cvt_pk_bf16_f32 v21, v186, v187
    v_cvt_pk_bf16_f32 v22, v188, v189
    v_cvt_pk_bf16_f32 v23, v190, v191
    ds_read_b128 v[136:139], v28
    s_waitcnt lgkmcnt(2)
    v_mfma_f32_32x32x16_bf16 v[96:111], v[128:131], v[16:19], 0
    v_mfma_f32_32x32x16_bf16 v[112:127], v[128:131], v[20:23], 0
    ds_read_b128 v[140:143], v28 offset:512
    ds_write_b128 v58, v[16:19]
    ds_write_b128 v58, v[20:23] offset:1024
    v_cvt_pk_bf16_f32 v224, v160, v161
    v_cvt_pk_bf16_f32 v225, v162, v163
    v_cvt_pk_bf16_f32 v226, v164, v165
    v_cvt_pk_bf16_f32 v227, v166, v167
    v_cvt_pk_bf16_f32 v228, v176, v177
    v_cvt_pk_bf16_f32 v229, v178, v179
    v_cvt_pk_bf16_f32 v230, v180, v181
    v_cvt_pk_bf16_f32 v231, v182, v183
    s_nop 0
    v_mfma_f32_32x32x16_bf16 v[192:207], v[152:155], v[224:227], 0
    v_mfma_f32_32x32x16_bf16 v[208:223], v[152:155], v[228:231], 0
    v_max3_f32 v30, v96, v97, v98
    v_max3_f32 v30, v30, v99, v100
    v_max3_f32 v30, v30, v101, v102
    v_max3_f32 v30, v30, v103, v104
    v_max3_f32 v30, v30, v105, v106
    v_max3_f32 v30, v30, v107, v108
    v_max3_f32 v30, v30, v109, v110
    v_max_f32 v30, v30, v111
    v_max3_f32 v31, v112, v113, v114
    v_max3_f32 v31, v31, v115, v116
    v_max3_f32 v31, v31, v117, v118
    v_max3_f32 v31, v31, v119, v120
    v_max3_f32 v31, v31, v121, v122
    v_max3_f32 v31, v31, v123, v124
    v_max3_f32 v31, v31, v125, v126
    v_max_f32 v31, v31, v127
    s_nop 1
    v_permlane32_swap_b32 v30, v31
    v_max_f32 v30, v30, v31
    v_sub_f32 v30, 3267887104, v30
    v_mov_b32 v31, v30
    s_nop 1
    v_permlane32_swap_b32 v30, v31
    ds_write_b64 v59, v[30:31] offset:2048
    s_waitcnt vmcnt(0)
    v_mov_b32 v14, 163552
    v_mov_b32 v15, 1
    s_mov_b64 exec, 1
    ds_add_u32 v14, v15 offset:4
    s_mov_b64 exec, -1
    s_mov_b32 s84, 10
L_astart:
    v_mov_b32 v32, v30
    v_mov_b32 v33, v30
    v_mov_b64 v[34:35], v[32:33]
    v_mov_b64 v[36:37], v[32:33]
    v_mov_b64 v[38:39], v[32:33]
    v_mov_b64 v[40:41], v[32:33]
    v_mov_b64 v[42:43], v[32:33]
    v_mov_b64 v[44:45], v[32:33]
    v_mov_b64 v[46:47], v[32:33]
    s_waitcnt lgkmcnt(0)
    s_nop 0
    v_mfma_f32_32x32x16_bf16 v[96:111], v[128:131], v[16:19], v[32:47]
    v_mov_b32 v48, v31
    v_mov_b32 v49, v31
    v_mov_b64 v[50:51], v[48:49]
    v_mov_b64 v[52:53], v[48:49]
    v_mov_b64 v[54:55], v[48:49]
    v_mov_b64 v[56:57], v[48:49]
    v_mov_b64 v[58:59], v[48:49]
    v_mov_b64 v[60:61], v[48:49]
    v_mov_b64 v[62:63], v[48:49]
    v_mov_b64 v[120:121], 0
    v_mov_b64 v[122:123], 0
    v_mov_b64 v[124:125], 0
    v_mov_b64 v[126:127], 0
    s_mov_b32 s66, 0
.p2align 3
L_attn:
    v_exp_f32 v96, v96
    v_exp_f32 v97, v97
    v_smfmac_f32_32x32x32_bf16 v[80:95], v[148:151], v[120:127], v24
    v_exp_f32 v98, v98
    ds_read_b128 v[132:135], v27 offset:1024
    ds_read_b128 v[144:147], v28 offset:1024
    ds_read_b128 v[148:151], v28 offset:1536
    v_exp_f32 v99, v99
    v_exp_f32 v100, v100
    v_mfma_f32_32x32x16_bf16 v[112:127], v[128:131], v[20:23], v[48:63]
    v_exp_f32 v101, v101
    v_exp_f32 v102, v102
    v_exp_f32 v103, v103
    v_exp_f32 v104, v104
    v_exp_f32 v105, v105
    v_exp_f32 v106, v106
    v_smfmac_f32_32x32x32_bf16 v[64:79], v[136:139], v[96:103], v24
    v_exp_f32 v107, v107
    v_exp_f32 v108, v108
    v_exp_f32 v109, v109
    v_exp_f32 v110, v110
    v_exp_f32 v111, v111
    v_exp_f32 v112, v112
    v_exp_f32 v113, v113
    v_smfmac_f32_32x32x32_bf16 v[64:79], v[140:143], v[104:111], v24
    v_exp_f32 v114, v114
    v_exp_f32 v115, v115
    v_exp_f32 v116, v116
    s_waitcnt lgkmcnt(0)
    v_mfma_f32_32x32x16_bf16 v[96:111], v[132:135], v[16:19], v[32:47]
    v_exp_f32 v117, v117
    v_exp_f32 v118, v118
    v_exp_f32 v119, v119
    v_exp_f32 v120, v120
    v_exp_f32 v121, v121
    v_exp_f32 v122, v122
    v_smfmac_f32_32x32x32_bf16 v[80:95], v[136:139], v[112:119], v24
    v_exp_f32 v123, v123
    v_exp_f32 v124, v124
    v_exp_f32 v125, v125
    v_exp_f32 v126, v126
    v_exp_f32 v127, v127
    v_exp_f32 v96, v96
    v_exp_f32 v97, v97
    v_smfmac_f32_32x32x32_bf16 v[80:95], v[140:143], v[120:127], v24
    v_exp_f32 v98, v98
    ds_read_b128 v[128:131], v27 offset:2048
    ds_read_b128 v[136:139], v28 offset:2048
    ds_read_b128 v[140:143], v28 offset:2560
    v_exp_f32 v99, v99
    v_exp_f32 v100, v100
    v_mfma_f32_32x32x16_bf16 v[112:127], v[132:135], v[20:23], v[48:63]
    v_exp_f32 v101, v101
    v_exp_f32 v102, v102
    v_exp_f32 v103, v103
    v_exp_f32 v104, v104
    v_exp_f32 v105, v105
    v_exp_f32 v106, v106
    v_smfmac_f32_32x32x32_bf16 v[64:79], v[144:147], v[96:103], v24
    v_exp_f32 v107, v107
    v_exp_f32 v108, v108
    v_exp_f32 v109, v109
    v_exp_f32 v110, v110
    v_exp_f32 v111, v111
    v_exp_f32 v112, v112
    v_exp_f32 v113, v113
    v_smfmac_f32_32x32x32_bf16 v[64:79], v[148:151], v[104:111], v24
    v_exp_f32 v114, v114
    v_exp_f32 v115, v115
    v_exp_f32 v116, v116
    s_waitcnt lgkmcnt(0)
    v_mfma_f32_32x32x16_bf16 v[96:111], v[128:131], v[16:19], v[32:47]
    v_exp_f32 v117, v117
    v_exp_f32 v118, v118
    v_exp_f32 v119, v119
    v_exp_f32 v120, v120
    v_exp_f32 v121, v121
    v_exp_f32 v122, v122
    v_smfmac_f32_32x32x32_bf16 v[80:95], v[144:147], v[112:119], v24
    v_exp_f32 v123, v123
    v_exp_f32 v124, v124
    v_exp_f32 v125, v125
    v_exp_f32 v126, v126
    v_exp_f32 v127, v127
    v_exp_f32 v96, v96
    v_exp_f32 v97, v97
    v_smfmac_f32_32x32x32_bf16 v[80:95], v[148:151], v[120:127], v24
    v_exp_f32 v98, v98
    ds_read_b128 v[132:135], v27 offset:3072
    ds_read_b128 v[144:147], v28 offset:3072
    ds_read_b128 v[148:151], v28 offset:3584
    v_exp_f32 v99, v99
    v_exp_f32 v100, v100
    v_mfma_f32_32x32x16_bf16 v[112:127], v[128:131], v[20:23], v[48:63]
    v_exp_f32 v101, v101
    v_exp_f32 v102, v102
    v_exp_f32 v103, v103
    v_exp_f32 v104, v104
    v_exp_f32 v105, v105
    v_exp_f32 v106, v106
    v_smfmac_f32_32x32x32_bf16 v[64:79], v[136:139], v[96:103], v24
    v_exp_f32 v107, v107
    v_exp_f32 v108, v108
    v_exp_f32 v109, v109
    v_exp_f32 v110, v110
    v_exp_f32 v111, v111
    v_exp_f32 v112, v112
    v_exp_f32 v113, v113
    v_smfmac_f32_32x32x32_bf16 v[64:79], v[140:143], v[104:111], v24
    v_exp_f32 v114, v114
    v_exp_f32 v115, v115
    v_exp_f32 v116, v116
    s_waitcnt lgkmcnt(0)
    v_mfma_f32_32x32x16_bf16 v[96:111], v[132:135], v[16:19], v[32:47]
    v_exp_f32 v117, v117
    v_exp_f32 v118, v118
    v_exp_f32 v119, v119
    v_exp_f32 v120, v120
    v_exp_f32 v121, v121
    v_exp_f32 v122, v122
    v_smfmac_f32_32x32x32_bf16 v[80:95], v[136:139], v[112:119], v24
    v_exp_f32 v123, v123
    v_exp_f32 v124, v124
    v_exp_f32 v125, v125
    v_exp_f32 v126, v126
    v_exp_f32 v127, v127
    v_exp_f32 v96, v96
    v_exp_f32 v97, v97
    v_smfmac_f32_32x32x32_bf16 v[80:95], v[140:143], v[120:127], v24
    v_exp_f32 v98, v98
    ds_read_b128 v[128:131], v27 offset:4096
    ds_read_b128 v[136:139], v28 offset:4096
    ds_read_b128 v[140:143], v28 offset:4608
    v_exp_f32 v99, v99
    v_exp_f32 v100, v100
    v_mfma_f32_32x32x16_bf16 v[112:127], v[132:135], v[20:23], v[48:63]
    v_exp_f32 v101, v101
    v_exp_f32 v102, v102
    v_exp_f32 v103, v103
    v_exp_f32 v104, v104
    v_exp_f32 v105, v105
    v_exp_f32 v106, v106
    v_smfmac_f32_32x32x32_bf16 v[64:79], v[144:147], v[96:103], v24
    v_exp_f32 v107, v107
    v_exp_f32 v108, v108
    v_exp_f32 v109, v109
    v_exp_f32 v110, v110
    v_exp_f32 v111, v111
    v_exp_f32 v112, v112
    v_exp_f32 v113, v113
    v_smfmac_f32_32x32x32_bf16 v[64:79], v[148:151], v[104:111], v24
    v_exp_f32 v114, v114
    v_exp_f32 v115, v115
    v_exp_f32 v116, v116
    s_waitcnt lgkmcnt(0)
    v_mfma_f32_32x32x16_bf16 v[96:111], v[128:131], v[16:19], v[32:47]
    v_exp_f32 v117, v117
    v_exp_f32 v118, v118
    v_exp_f32 v119, v119
    v_exp_f32 v120, v120
    v_exp_f32 v121, v121
    v_exp_f32 v122, v122
    v_smfmac_f32_32x32x32_bf16 v[80:95], v[144:147], v[112:119], v24
    v_exp_f32 v123, v123
    v_exp_f32 v124, v124
    v_add_u32 v27, 4096, v27
    v_add_u32 v28, v29, v28
    v_exp_f32 v125, v125
    s_add_u32 s66, s66, 1
    s_cmp_le_u32 s66, s84
    v_exp_f32 v126, v126
    v_exp_f32 v127, v127
    s_cbranch_scc1 L_hook
L_hookret:
    s_cmp_lt_u32 s66, s65
    s_cbranch_scc1 L_attn
    v_smfmac_f32_32x32x32_bf16 v[80:95], v[148:151], v[120:127], v24
    s_mul_i32 s74, s61, 2560
    s_add_u32 s74, s74, 148480
    s_cmp_eq_u32 s62, 0
    s_cselect_b32 s75, s99, s74
    s_cselect_b32 s76, s74, s99
    v_lshlrev_b32 v8, 2, v1
    v_add_u32 v5, s75, v4
    v_add_u32 v6, s75, v8
    v_add_u32 v7, s76, v4
    v_add_u32 v8, s76, v8
    s_nop 1
    ds_write_b128 v5, v[80:83]
    ds_write_b128 v5, v[84:87] offset:1024
    ds_write_b32 v6, v88 offset:2048
    s_waitcnt vmcnt(0)
    s_cmp_lg_u32 s62, 0
    s_cbranch_scc1 L_join
    s_setprio 2
    s_mov_b32 s85, 0x20000
    s_lshl_b32 s73, s61, 13
    s_add_u32 s73, s73, s16
    s_add_u32 s73, s73, 0
    s_add_u32 s76, s73, 4096
    buffer_load_dwordx4 v[32:35], v4, s[40:43], s73 offen offset:0 sc1
    buffer_load_dwordx4 v[36:39], v4, s[40:43], s73 offen offset:1024 sc1
    buffer_load_dwordx4 v[40:43], v4, s[40:43], s73 offen offset:2048 sc1
    buffer_load_dwordx4 v[44:47], v4, s[40:43], s73 offen offset:3072 sc1
    buffer_load_dwordx4 v[48:51], v4, s[40:43], s76 offen offset:0 sc1
    buffer_load_dwordx4 v[52:55], v4, s[40:43], s76 offen offset:1024 sc1
    buffer_load_dwordx4 v[56:59], v4, s[40:43], s76 offen offset:2048 sc1
    buffer_load_dwordx4 v[60:63], v4, s[40:43], s76 offen offset:3072 sc1
L_achk1:
    v_max3_u32 v12, v224, v225, v226
    v_max_u32 v12, v12, v227
    v_max3_u32 v12, v12, v228, v229
    v_max3_u32 v12, v12, v230, v231
    v_max3_u32 v12, v12, v232, v233
    v_max3_u32 v12, v12, v234, v235
    v_max3_u32 v12, v12, v236, v237
    v_max3_u32 v12, v12, v238, v239
    v_max3_u32 v12, v12, v240, v241
    v_max3_u32 v12, v12, v242, v243
    v_max3_u32 v12, v12, v244, v245
    v_max3_u32 v12, v12, v246, v247
    v_max3_u32 v12, v12, v248, v249
    v_max3_u32 v12, v12, v250, v251
    v_max3_u32 v12, v12, v252, v253
    v_max3_u32 v12, v12, v254, v255
    v_cmp_eq_u32 vcc, -1, v12
    s_sub_u32 s85, s85, 1
    s_cbranch_scc1 L_ag1
    s_cbranch_vccnz L_are1
L_ag1:
    s_cselect_b32 s85, 0, s85
    s_setprio 0
    v_mfma_f32_32x32x16_bf16 v[128:143], v[160:163], v[224:227], 0
    v_mfma_f32_32x32x16_bf16 v[144:159], v[164:167], v[224:227], 0
    v_mfma_f32_32x32x16_bf16 v[128:143], v[168:171], v[228:231], v[128:143]
    v_mfma_f32_32x32x16_bf16 v[144:159], v[172:175], v[228:231], v[144:159]
    v_mfma_f32_32x32x16_bf16 v[128:143], v[176:179], v[232:235], v[128:143]
    v_mfma_f32_32x32x16_bf16 v[144:159], v[180:183], v[232:235], v[144:159]
    v_mfma_f32_32x32x16_bf16 v[128:143], v[184:187], v[236:239], v[128:143]
    v_mfma_f32_32x32x16_bf16 v[144:159], v[188:191], v[236:239], v[144:159]
    v_mfma_f32_32x32x16_bf16 v[128:143], v[192:195], v[240:243], v[128:143]
    v_mfma_f32_32x32x16_bf16 v[144:159], v[196:199], v[240:243], v[144:159]
    v_mfma_f32_32x32x16_bf16 v[128:143], v[200:203], v[244:247], v[128:143]
    v_mfma_f32_32x32x16_bf16 v[144:159], v[204:207], v[244:247], v[144:159]
    v_mfma_f32_32x32x16_bf16 v[128:143], v[208:211], v[248:251], v[128:143]
    v_mfma_f32_32x32x16_bf16 v[144:159], v[212:215], v[248:251], v[144:159]
    v_mfma_f32_32x32x16_bf16 v[128:143], v[216:219], v[252:255], v[128:143]
    v_mfma_f32_32x32x16_bf16 v[144:159], v[220:223], v[252:255], v[144:159]
L_join:
    s_waitcnt lgkmcnt(0)
    s_barrier
    ds_read_b128 v[80:83], v7
    ds_read_b128 v[84:87], v7 offset:1024
    ds_read_b32 v88, v8 offset:2048
    s_mov_b32 s74, 1568669696
    s_setprio 0
    s_lshl_b32 s71, s62, 15
    s_add_u32 s71, s71, s98
    s_add_u32 s71, s71, 2097152
    v_sub_f32 v31, 1.0, v25
    v_mul_f32 v31, 813694976, v31
    s_waitcnt lgkmcnt(0)
    v_add_f32 v72, v72, v88
    v_cmp_ngt_f32 vcc, s74, v72
    v_pk_add_f32 v[64:65], v[64:65], v[80:81]
    v_pk_add_f32 v[66:67], v[66:67], v[82:83]
    v_pk_add_f32 v[68:69], v[68:69], v[84:85]
    v_pk_add_f32 v[70:71], v[70:71], v[86:87]
    s_cbranch_vccnz L_fallback
L_fbret:
    v_rcp_f32 v30, v72
    s_lshl_b32 s74, s77, 10
    v_mul_f32 v30, v30, v31
    v_pk_mul_f32 v[64:65], v[64:65], v[30:31] op_sel_hi:[1,0]
    v_pk_mul_f32 v[66:67], v[66:67], v[30:31] op_sel_hi:[1,0]
    v_pk_mul_f32 v[68:69], v[68:69], v[30:31] op_sel_hi:[1,0]
    v_pk_mul_f32 v[70:71], v[70:71], v[30:31] op_sel_hi:[1,0]
    v_cvt_pk_bf16_f32 v80, v64, v65
    v_cvt_pk_bf16_f32 v81, v66, v67
    v_cvt_pk_bf16_f32 v82, v68, v69
    v_cvt_pk_bf16_f32 v83, v70, v71
    v_min_u32 v80, -2, v80
    v_min_u32 v81, -2, v81
    v_min_u32 v82, -2, v82
    v_min_u32 v83, -2, v83
    s_add_u32 s74, s71, s74
    buffer_store_dwordx4 v[80:83], v4, s[40:43], s74 offen sc1
    s_lshl_b32 s75, s61, 13
    s_add_u32 s71, s71, s75
    s_sub_u32 s71, s71, s98
    s_add_u32 s71, s71, s16
    s_add_u32 s72, s71, 4096
    s_mov_b32 s85, 0x20000
    v_add_u32 v7, s75, v4
    s_cmp_lg_u32 s62, 0
    s_cbranch_scc1 L_tail1
    ds_write_b128 v7, v[128:131] offset:32768
    ds_write_b128 v7, v[132:135] offset:33792
    ds_write_b128 v7, v[136:139] offset:34816
    ds_write_b128 v7, v[140:143] offset:35840
    ds_write_b128 v7, v[144:147] offset:36864
    ds_write_b128 v7, v[148:151] offset:37888
    ds_write_b128 v7, v[152:155] offset:38912
    ds_write_b128 v7, v[156:159] offset:39936
    s_waitcnt vmcnt(1) lgkmcnt(0)
    s_barrier
L_achk0:
    v_max3_u32 v12, v32, v33, v34
    v_max_u32 v12, v12, v35
    v_max3_u32 v12, v12, v36, v37
    v_max3_u32 v12, v12, v38, v39
    v_max3_u32 v12, v12, v40, v41
    v_max3_u32 v12, v12, v42, v43
    v_max3_u32 v12, v12, v44, v45
    v_max3_u32 v12, v12, v46, v47
    v_max3_u32 v12, v12, v48, v49
    v_max3_u32 v12, v12, v50, v51
    v_max3_u32 v12, v12, v52, v53
    v_max3_u32 v12, v12, v54, v55
    v_max3_u32 v12, v12, v56, v57
    v_max3_u32 v12, v12, v58, v59
    v_max3_u32 v12, v12, v60, v61
    v_max3_u32 v12, v12, v62, v63
    v_cmp_eq_u32 vcc, -1, v12
    s_sub_u32 s85, s85, 1
    s_cbranch_scc1 L_ag0
    s_cbranch_vccnz L_are0
L_ag0:
    s_cselect_b32 s85, 0, s85
    v_mfma_f32_32x32x16_bf16 v[96:111], v[160:163], v[32:35], 0
    v_mfma_f32_32x32x16_bf16 v[112:127], v[164:167], v[32:35], 0
    v_mfma_f32_32x32x16_bf16 v[96:111], v[168:171], v[36:39], v[96:111]
    v_mfma_f32_32x32x16_bf16 v[112:127], v[172:175], v[36:39], v[112:127]
    v_mfma_f32_32x32x16_bf16 v[96:111], v[176:179], v[40:43], v[96:111]
    v_mfma_f32_32x32x16_bf16 v[112:127], v[180:183], v[40:43], v[112:127]
    v_mfma_f32_32x32x16_bf16 v[96:111], v[184:187], v[44:47], v[96:111]
    v_mfma_f32_32x32x16_bf16 v[112:127], v[188:191], v[44:47], v[112:127]
    v_mfma_f32_32x32x16_bf16 v[96:111], v[192:195], v[48:51], v[96:111]
    v_mfma_f32_32x32x16_bf16 v[112:127], v[196:199], v[48:51], v[112:127]
    v_mfma_f32_32x32x16_bf16 v[96:111], v[200:203], v[52:55], v[96:111]
    v_mfma_f32_32x32x16_bf16 v[112:127], v[204:207], v[52:55], v[112:127]
    v_mfma_f32_32x32x16_bf16 v[96:111], v[208:211], v[56:59], v[96:111]
    v_mfma_f32_32x32x16_bf16 v[112:127], v[212:215], v[56:59], v[112:127]
    v_mfma_f32_32x32x16_bf16 v[96:111], v[216:219], v[60:63], v[96:111]
    v_mfma_f32_32x32x16_bf16 v[112:127], v[220:223], v[60:63], v[112:127]
    s_branch L_tail2
L_tail1:
    s_barrier
    ds_read_b128 v[96:99], v7 offset:32768
    ds_read_b128 v[100:103], v7 offset:33792
    ds_read_b128 v[104:107], v7 offset:34816
    ds_read_b128 v[108:111], v7 offset:35840
    ds_read_b128 v[112:115], v7 offset:36864
    ds_read_b128 v[116:119], v7 offset:37888
    ds_read_b128 v[120:123], v7 offset:38912
    ds_read_b128 v[124:127], v7 offset:39936
L_tail2:
    s_waitcnt vmcnt(0)
    buffer_load_dwordx4 v[224:227], v4, s[40:43], s71 offen offset:0 sc1
    buffer_load_dwordx4 v[228:231], v4, s[40:43], s71 offen offset:1024 sc1
    buffer_load_dwordx4 v[232:235], v4, s[40:43], s71 offen offset:2048 sc1
    buffer_load_dwordx4 v[236:239], v4, s[40:43], s71 offen offset:3072 sc1
    buffer_load_dwordx4 v[240:243], v4, s[40:43], s72 offen offset:0 sc1
    buffer_load_dwordx4 v[244:247], v4, s[40:43], s72 offen offset:1024 sc1
    buffer_load_dwordx4 v[248:251], v4, s[40:43], s72 offen offset:2048 sc1
    buffer_load_dwordx4 v[252:255], v4, s[40:43], s72 offen offset:3072 sc1
L_tail3:
    ds_read_b64_tr_b16 v[160:161], v10 offset:0
    ds_read_b64_tr_b16 v[162:163], v10 offset:512
    ds_read_b64_tr_b16 v[164:165], v11 offset:0
    ds_read_b64_tr_b16 v[166:167], v11 offset:512
    ds_read_b64_tr_b16 v[168:169], v10 offset:2048
    ds_read_b64_tr_b16 v[170:171], v10 offset:2560
    ds_read_b64_tr_b16 v[172:173], v11 offset:2048
    ds_read_b64_tr_b16 v[174:175], v11 offset:2560
    s_waitcnt lgkmcnt(3)
    ds_read_b64_tr_b16 v[176:177], v10 offset:4096
    ds_read_b64_tr_b16 v[178:179], v10 offset:4608
    ds_read_b64_tr_b16 v[180:181], v11 offset:4096
    ds_read_b64_tr_b16 v[182:183], v11 offset:4608
    ds_read_b64_tr_b16 v[184:185], v10 offset:6144
    ds_read_b64_tr_b16 v[186:187], v10 offset:6656
    ds_read_b64_tr_b16 v[188:189], v11 offset:6144
    ds_read_b64_tr_b16 v[190:191], v11 offset:6656
    ds_read_b64_tr_b16 v[192:193], v10 offset:8192
    ds_read_b64_tr_b16 v[194:195], v10 offset:8704
    ds_read_b64_tr_b16 v[196:197], v11 offset:8192
    ds_read_b64_tr_b16 v[198:199], v11 offset:8704
    s_waitcnt lgkmcnt(3)
    ds_read_b64_tr_b16 v[200:201], v10 offset:10240
    ds_read_b64_tr_b16 v[202:203], v10 offset:10752
    ds_read_b64_tr_b16 v[204:205], v11 offset:10240
    ds_read_b64_tr_b16 v[206:207], v11 offset:10752
    ds_read_b64_tr_b16 v[208:209], v10 offset:12288
    ds_read_b64_tr_b16 v[210:211], v10 offset:12800
    ds_read_b64_tr_b16 v[212:213], v11 offset:12288
    ds_read_b64_tr_b16 v[214:215], v11 offset:12800
    ds_read_b64_tr_b16 v[216:217], v10 offset:14336
    ds_read_b64_tr_b16 v[218:219], v10 offset:14848
    ds_read_b64_tr_b16 v[220:221], v11 offset:14336
    ds_read_b64_tr_b16 v[222:223], v11 offset:14848
    s_lshl_b32 s74, s62, 15
    s_add_u32 s74, s74, 98304
    s_lshl_b32 s75, s61, 11
    s_add_u32 s74, s74, s75
    v_add_u32 v7, s74, v7
    v_xor_b32 v65, 8192, v7
    v_xor_b32 v69, 2048, v7
    v_xor_b32 v66, 16384, v7
    v_xor_b32 v70, 4096, v7
    v_xor_b32 v67, 24576, v7
    v_xor_b32 v71, 6144, v7
    v_lshlrev_b32 v13, 10, v2
    v_lshl_add_u32 v13, v3, 4, v13
    s_lshl_b32 s75, s14, 16
    s_lshl_b32 s76, s62, 15
    s_add_u32 s75, s75, s76
    s_lshl_b32 s76, s15, 7
    s_add_u32 s75, s75, s76
    s_lshl_b32 s76, s61, 5
    s_add_u32 s75, s75, s76
    s_waitcnt vmcnt(4)
L_bchk0:
    v_max3_u32 v12, v224, v225, v226
    v_max_u32 v12, v12, v227
    v_max3_u32 v12, v12, v228, v229
    v_max3_u32 v12, v12, v230, v231
    v_max3_u32 v12, v12, v232, v233
    v_max3_u32 v12, v12, v234, v235
    v_max3_u32 v12, v12, v236, v237
    v_max3_u32 v12, v12, v238, v239
    v_cmp_eq_u32 vcc, -1, v12
    s_sub_u32 s85, s85, 1
    s_cbranch_scc1 L_bg0
    s_cbranch_vccz L_bg0
    buffer_load_dwordx4 v[224:227], v4, s[40:43], s71 offen offset:0 sc1
    buffer_load_dwordx4 v[228:231], v4, s[40:43], s71 offen offset:1024 sc1
    buffer_load_dwordx4 v[232:235], v4, s[40:43], s71 offen offset:2048 sc1
    buffer_load_dwordx4 v[236:239], v4, s[40:43], s71 offen offset:3072 sc1
    s_waitcnt vmcnt(0)
    s_branch L_bchk0
L_bg0:
    s_cselect_b32 s85, 0, s85
    s_waitcnt lgkmcnt(0)
    v_mfma_f32_32x32x16_bf16 v[112:127], v[164:167], v[224:227], v[112:127]
    v_mfma_f32_32x32x16_bf16 v[112:127], v[172:175], v[228:231], v[112:127]
    v_mfma_f32_32x32x16_bf16 v[112:127], v[180:183], v[232:235], v[112:127]
    v_mfma_f32_32x32x16_bf16 v[112:127], v[188:191], v[236:239], v[112:127]
    v_mfma_f32_32x32x16_bf16 v[96:111], v[160:163], v[224:227], v[96:111]
    v_mfma_f32_32x32x16_bf16 v[96:111], v[168:171], v[228:231], v[96:111]
    v_mfma_f32_32x32x16_bf16 v[96:111], v[176:179], v[232:235], v[96:111]
    v_mfma_f32_32x32x16_bf16 v[96:111], v[184:187], v[236:239], v[96:111]
    s_waitcnt vmcnt(0)
L_bchk1:
    v_max3_u32 v12, v240, v241, v242
    v_max_u32 v12, v12, v243
    v_max3_u32 v12, v12, v244, v245
    v_max3_u32 v12, v12, v246, v247
    v_max3_u32 v12, v12, v248, v249
    v_max3_u32 v12, v12, v250, v251
    v_max3_u32 v12, v12, v252, v253
    v_max3_u32 v12, v12, v254, v255
    v_cmp_eq_u32 vcc, -1, v12
    s_sub_u32 s85, s85, 1
    s_cbranch_scc1 L_bg1
    s_cbranch_vccz L_bg1
    buffer_load_dwordx4 v[240:243], v4, s[40:43], s72 offen offset:0 sc1
    buffer_load_dwordx4 v[244:247], v4, s[40:43], s72 offen offset:1024 sc1
    buffer_load_dwordx4 v[248:251], v4, s[40:43], s72 offen offset:2048 sc1
    buffer_load_dwordx4 v[252:255], v4, s[40:43], s72 offen offset:3072 sc1
    s_waitcnt vmcnt(0)
    s_branch L_bchk1
L_bg1:
    s_cselect_b32 s85, 0, s85
    v_mfma_f32_32x32x16_bf16 v[112:127], v[196:199], v[240:243], v[112:127]
    v_mfma_f32_32x32x16_bf16 v[112:127], v[204:207], v[244:247], v[112:127]
    v_mfma_f32_32x32x16_bf16 v[112:127], v[212:215], v[248:251], v[112:127]
    v_mfma_f32_32x32x16_bf16 v[112:127], v[220:223], v[252:255], v[112:127]
    v_mfma_f32_32x32x16_bf16 v[96:111], v[192:195], v[240:243], v[96:111]
    v_mfma_f32_32x32x16_bf16 v[96:111], v[200:203], v[244:247], v[96:111]
    v_mfma_f32_32x32x16_bf16 v[96:111], v[208:211], v[248:251], v[96:111]
    v_mfma_f32_32x32x16_bf16 v[96:111], v[216:219], v[252:255], v[96:111]
    s_nop 7
    ds_write_b128 v66, v[112:115] offset:0
    ds_write_b128 v66, v[116:119] offset:1024
    ds_write_b128 v67, v[120:123] offset:0
    ds_write_b128 v67, v[124:127] offset:1024
    ds_write_b128 v65, v[104:107] offset:0
    ds_write_b128 v65, v[108:111] offset:1024
    s_waitcnt lgkmcnt(0)
    s_barrier
    ds_read_b128 v[40:43], v69 offset:0
    ds_read_b128 v[44:47], v69 offset:1024
    ds_read_b128 v[48:51], v70 offset:0
    ds_read_b128 v[52:55], v70 offset:1024
    ds_read_b128 v[56:59], v71 offset:0
    ds_read_b128 v[60:63], v71 offset:1024
    s_waitcnt lgkmcnt(4)
    v_pk_add_f32 v[96:97], v[96:97], v[40:41]
    v_pk_add_f32 v[98:99], v[98:99], v[42:43]
    v_pk_add_f32 v[100:101], v[100:101], v[44:45]
    v_pk_add_f32 v[102:103], v[102:103], v[46:47]
    s_waitcnt lgkmcnt(0)
    v_pk_add_f32 v[48:49], v[48:49], v[56:57]
    v_pk_add_f32 v[50:51], v[50:51], v[58:59]
    v_pk_add_f32 v[52:53], v[52:53], v[60:61]
    v_pk_add_f32 v[54:55], v[54:55], v[62:63]
    v_pk_add_f32 v[96:97], v[96:97], v[48:49]
    v_pk_add_f32 v[98:99], v[98:99], v[50:51]
    v_pk_add_f32 v[100:101], v[100:101], v[52:53]
    v_pk_add_f32 v[102:103], v[102:103], v[54:55]
    v_cvt_pk_bf16_f32 v64, v96, v97
    v_cvt_pk_bf16_f32 v65, v98, v99
    v_cvt_pk_bf16_f32 v66, v100, v101
    v_cvt_pk_bf16_f32 v67, v102, v103
    buffer_store_dwordx4 v[64:67], v13, s[52:55], s75 offen
L_end:
    s_endpgm
L_role1:
    s_setprio 2
    s_lshl_b32 s76, s61, 10
    v_cvt_pk_bf16_f32 v224, v160, v161
    v_cvt_pk_bf16_f32 v225, v162, v163
    v_cvt_pk_bf16_f32 v226, v164, v165
    v_cvt_pk_bf16_f32 v227, v166, v167
    v_cvt_pk_bf16_f32 v228, v176, v177
    v_cvt_pk_bf16_f32 v229, v178, v179
    v_cvt_pk_bf16_f32 v230, v180, v181
    v_cvt_pk_bf16_f32 v231, v182, v183
    s_nop 0
    v_mfma_f32_32x32x16_bf16 v[192:207], v[152:155], v[224:227], 0
    v_mfma_f32_32x32x16_bf16 v[208:223], v[152:155], v[228:231], 0
    v_cvt_pk_bf16_f32 v16, v168, v169
    v_cvt_pk_bf16_f32 v17, v170, v171
    v_cvt_pk_bf16_f32 v18, v172, v173
    v_cvt_pk_bf16_f32 v19, v174, v175
    v_cvt_pk_bf16_f32 v20, v184, v185
    v_cvt_pk_bf16_f32 v21, v186, v187
    v_cvt_pk_bf16_f32 v22, v188, v189
    v_cvt_pk_bf16_f32 v23, v190, v191
    s_add_u32 s73, s76, 73728
    s_mov_b32 m0, s73
    s_nop 0
    buffer_load_dwordx4 v4, s[40:43], s73 offen sc1 lds
    v_max3_f32 v232, v192, v193, v194
    v_max3_f32 v232, v232, v195, v196
    v_max3_f32 v232, v232, v197, v198
    v_max_f32 v232, v232, v199
    v_max3_f32 v234, v200, v201, v202
    v_max3_f32 v234, v234, v203, v204
    v_max3_f32 v234, v234, v205, v206
    v_max_f32 v234, v234, v207
    s_add_u32 s73, s76, 77824
    s_mov_b32 m0, s73
    s_nop 0
    buffer_load_dwordx4 v4, s[40:43], s73 offen sc1 lds
    s_nop 1
    v_permlane32_swap_b32 v232, v234
    v_max_f32 v232, v232, v234
    v_mul_f32 v232, s80, v232
    v_mov_b32 v234, v232
    s_nop 1
    v_permlane32_swap_b32 v232, v234
    v_pk_fma_f32 v[192:193], v[192:193], s[80:81], v[232:233] op_sel_hi:[1,1,0] neg_lo:[0,0,1] neg_hi:[0,0,1]
    v_pk_fma_f32 v[194:195], v[194:195], s[80:81], v[232:233] op_sel_hi:[1,1,0] neg_lo:[0,0,1] neg_hi:[0,0,1]
    v_pk_fma_f32 v[196:197], v[196:197], s[80:81], v[232:233] op_sel_hi:[1,1,0] neg_lo:[0,0,1] neg_hi:[0,0,1]
    v_pk_fma_f32 v[198:199], v[198:199], s[80:81], v[232:233] op_sel_hi:[1,1,0] neg_lo:[0,0,1] neg_hi:[0,0,1]
    v_pk_fma_f32 v[200:201], v[200:201], s[80:81], v[234:235] op_sel_hi:[1,1,0] neg_lo:[0,0,1] neg_hi:[0,0,1]
    v_pk_fma_f32 v[202:203], v[202:203], s[80:81], v[234:235] op_sel_hi:[1,1,0] neg_lo:[0,0,1] neg_hi:[0,0,1]
    v_pk_fma_f32 v[204:205], v[204:205], s[80:81], v[234:235] op_sel_hi:[1,1,0] neg_lo:[0,0,1] neg_hi:[0,0,1]
    v_pk_fma_f32 v[206:207], v[206:207], s[80:81], v[234:235] op_sel_hi:[1,1,0] neg_lo:[0,0,1] neg_hi:[0,0,1]
    s_add_u32 s73, s76, 81920
    s_mov_b32 m0, s73
    s_nop 0
    buffer_load_dwordx4 v4, s[40:43], s73 offen sc1 lds
    v_exp_f32 v192, v192
    v_exp_f32 v193, v193
    v_exp_f32 v194, v194
    v_exp_f32 v195, v195
    v_exp_f32 v196, v196
    v_exp_f32 v197, v197
    s_add_u32 s73, s76, 86016
    s_mov_b32 m0, s73
    s_nop 0
    buffer_load_dwordx4 v4, s[40:43], s73 offen sc1 lds
    v_exp_f32 v198, v198
    v_exp_f32 v199, v199
    v_exp_f32 v200, v200
    v_exp_f32 v201, v201
    v_exp_f32 v202, v202
    s_add_u32 s73, s76, 90112
    s_mov_b32 m0, s73
    s_nop 0
    buffer_load_dwordx4 v4, s[40:43], s73 offen sc1 lds
    v_exp_f32 v203, v203
    v_exp_f32 v204, v204
    v_exp_f32 v205, v205
    v_exp_f32 v206, v206
    v_exp_f32 v207, v207
    v_pk_add_f32 v[236:237], v[192:193], v[194:195]
    v_pk_add_f32 v[238:239], v[196:197], v[198:199]
    v_pk_add_f32 v[236:237], v[236:237], v[238:239]
    v_add_f32 v232, v236, v237
    v_pk_add_f32 v[236:237], v[200:201], v[202:203]
    v_pk_add_f32 v[238:239], v[204:205], v[206:207]
    v_pk_add_f32 v[236:237], v[236:237], v[238:239]
    v_add_f32 v234, v236, v237
    s_add_u32 s73, s76, 94208
    s_mov_b32 m0, s73
    s_nop 0
    buffer_load_dwordx4 v4, s[40:43], s73 offen sc1 lds
    s_nop 1
    v_permlane32_swap_b32 v232, v234
    v_add_f32 v232, v232, v234
    v_rcp_f32 v232, v232
    s_nop 0
    v_mov_b32 v234, v232
    s_nop 1
    v_permlane32_swap_b32 v232, v234
    v_pk_mul_f32 v[192:193], v[192:193], v[232:233] op_sel_hi:[1,0]
    v_pk_mul_f32 v[194:195], v[194:195], v[232:233] op_sel_hi:[1,0]
    v_pk_mul_f32 v[196:197], v[196:197], v[232:233] op_sel_hi:[1,0]
    v_pk_mul_f32 v[198:199], v[198:199], v[232:233] op_sel_hi:[1,0]
    v_pk_mul_f32 v[200:201], v[200:201], v[234:235] op_sel_hi:[1,0]
    v_pk_mul_f32 v[202:203], v[202:203], v[234:235] op_sel_hi:[1,0]
    v_pk_mul_f32 v[204:205], v[204:205], v[234:235] op_sel_hi:[1,0]
    v_pk_mul_f32 v[206:207], v[206:207], v[234:235] op_sel_hi:[1,0]
    s_add_u32 s73, s76, 98304
    s_mov_b32 m0, s73
    s_nop 0
    buffer_load_dwordx4 v4, s[40:43], s73 offen sc1 lds
    v_cvt_pk_bf16_f32 v240, v192, v193
    v_cvt_pk_bf16_f32 v241, v194, v195
    v_cvt_pk_bf16_f32 v242, v196, v197
    v_cvt_pk_bf16_f32 v243, v198, v199
    v_cvt_pk_bf16_f32 v244, v200, v201
    v_cvt_pk_bf16_f32 v245, v202, v203
    v_cvt_pk_bf16_f32 v246, v204, v205
    v_cvt_pk_bf16_f32 v247, v206, v207
    v_max3_f32 v232, v208, v209, v210
    v_max3_f32 v232, v232, v211, v212
    v_max3_f32 v232, v232, v213, v214
    v_max_f32 v232, v232, v215
    v_max3_f32 v234, v216, v217, v218
    v_max3_f32 v234, v234, v219, v220
    v_max3_f32 v234, v234, v221, v222
    v_max_f32 v234, v234, v223
    s_add_u32 s73, s76, 102400
    s_mov_b32 m0, s73
    s_nop 0
    buffer_load_dwordx4 v4, s[40:43], s73 offen sc1 lds
    s_nop 1
    v_permlane32_swap_b32 v232, v234
    v_max_f32 v232, v232, v234
    v_mul_f32 v232, s80, v232
    v_mov_b32 v234, v232
    s_nop 1
    v_permlane32_swap_b32 v232, v234
    v_pk_fma_f32 v[208:209], v[208:209], s[80:81], v[232:233] op_sel_hi:[1,1,0] neg_lo:[0,0,1] neg_hi:[0,0,1]
    v_pk_fma_f32 v[210:211], v[210:211], s[80:81], v[232:233] op_sel_hi:[1,1,0] neg_lo:[0,0,1] neg_hi:[0,0,1]
    v_pk_fma_f32 v[212:213], v[212:213], s[80:81], v[232:233] op_sel_hi:[1,1,0] neg_lo:[0,0,1] neg_hi:[0,0,1]
    v_pk_fma_f32 v[214:215], v[214:215], s[80:81], v[232:233] op_sel_hi:[1,1,0] neg_lo:[0,0,1] neg_hi:[0,0,1]
    v_pk_fma_f32 v[216:217], v[216:217], s[80:81], v[234:235] op_sel_hi:[1,1,0] neg_lo:[0,0,1] neg_hi:[0,0,1]
    v_pk_fma_f32 v[218:219], v[218:219], s[80:81], v[234:235] op_sel_hi:[1,1,0] neg_lo:[0,0,1] neg_hi:[0,0,1]
    v_pk_fma_f32 v[220:221], v[220:221], s[80:81], v[234:235] op_sel_hi:[1,1,0] neg_lo:[0,0,1] neg_hi:[0,0,1]
    v_pk_fma_f32 v[222:223], v[222:223], s[80:81], v[234:235] op_sel_hi:[1,1,0] neg_lo:[0,0,1] neg_hi:[0,0,1]
    s_add_u32 s73, s76, 106496
    s_mov_b32 m0, s73
    s_nop 0
    buffer_load_dwordx4 v4, s[40:43], s73 offen sc1 lds
    v_exp_f32 v208, v208
    v_exp_f32 v209, v209
    v_exp_f32 v210, v210
    v_exp_f32 v211, v211
    v_exp_f32 v212, v212
    v_exp_f32 v213, v213
    s_add_u32 s73, s76, 110592
    s_mov_b32 m0, s73
    s_nop 0
    buffer_load_dwordx4 v4, s[40:43], s73 offen sc1 lds
    v_exp_f32 v214, v214
    v_exp_f32 v215, v215
    v_exp_f32 v216, v216
    v_exp_f32 v217, v217
    v_exp_f32 v218, v218
    v_exp_f32 v219, v219
    v_exp_f32 v220, v220
    v_exp_f32 v221, v221
    v_exp_f32 v222, v222
    v_exp_f32 v223, v223
    v_pk_add_f32 v[236:237], v[208:209], v[210:211]
    v_pk_add_f32 v[238:239], v[212:213], v[214:215]
    v_pk_add_f32 v[236:237], v[236:237], v[238:239]
    v_add_f32 v232, v236, v237
    v_pk_add_f32 v[236:237], v[216:217], v[218:219]
    v_pk_add_f32 v[238:239], v[220:221], v[222:223]
    v_pk_add_f32 v[236:237], v[236:237], v[238:239]
    v_add_f32 v234, v236, v237
    s_nop 1
    v_permlane32_swap_b32 v232, v234
    v_add_f32 v232, v232, v234
    v_rcp_f32 v232, v232
    s_nop 0
    v_mov_b32 v234, v232
    s_nop 1
    v_permlane32_swap_b32 v232, v234
    v_pk_mul_f32 v[208:209], v[208:209], v[232:233] op_sel_hi:[1,0]
    v_pk_mul_f32 v[210:211], v[210:211], v[232:233] op_sel_hi:[1,0]
    v_pk_mul_f32 v[212:213], v[212:213], v[232:233] op_sel_hi:[1,0]
    v_pk_mul_f32 v[214:215], v[214:215], v[232:233] op_sel_hi:[1,0]
    v_pk_mul_f32 v[216:217], v[216:217], v[234:235] op_sel_hi:[1,0]
    v_pk_mul_f32 v[218:219], v[218:219], v[234:235] op_sel_hi:[1,0]
    v_pk_mul_f32 v[220:221], v[220:221], v[234:235] op_sel_hi:[1,0]
    v_pk_mul_f32 v[222:223], v[222:223], v[234:235] op_sel_hi:[1,0]
    v_cvt_pk_bf16_f32 v248, v208, v209
    v_cvt_pk_bf16_f32 v249, v210, v211
    v_cvt_pk_bf16_f32 v250, v212, v213
    v_cvt_pk_bf16_f32 v251, v214, v215
    v_cvt_pk_bf16_f32 v252, v216, v217
    v_cvt_pk_bf16_f32 v253, v218, v219
    v_cvt_pk_bf16_f32 v254, v220, v221
    v_cvt_pk_bf16_f32 v255, v222, v223
    v_mov_b32 v232, 0x3f803f80
    v_mov_b32 v233, 0x3f803f80
    v_mov_b32 v234, 0x3f803f80
    v_mov_b32 v235, 0x3f803f80
    ds_write_b128 v56, v[232:235] offset:3072
    ds_write_b128 v56, v[240:243]
    ds_write_b128 v56, v[244:247] offset:1024
    ds_write_b128 v56, v[16:19] offset:2048
    ds_read_b64_tr_b16 v[160:161], v57 offset:2048
    ds_read_b64_tr_b16 v[176:177], v57 offset:0
    ds_read_b64_tr_b16 v[162:163], v57 offset:2176
    ds_read_b64_tr_b16 v[178:179], v57 offset:128
    ds_read_b64_tr_b16 v[164:165], v57 offset:2560
    ds_read_b64_tr_b16 v[180:181], v57 offset:512
    ds_read_b64_tr_b16 v[166:167], v57 offset:2688
    ds_read_b64_tr_b16 v[182:183], v57 offset:640
    s_waitcnt lgkmcnt(4)
    ds_write_b128 v56, v[248:251]
    ds_write_b128 v56, v[252:255] offset:1024
    ds_write_b128 v56, v[20:23] offset:2048
    ds_read_b64_tr_b16 v[168:169], v57 offset:2048
    ds_read_b64_tr_b16 v[184:185], v57 offset:0
    ds_read_b64_tr_b16 v[170:171], v57 offset:2176
    ds_read_b64_tr_b16 v[186:187], v57 offset:128
    ds_read_b64_tr_b16 v[172:173], v57 offset:2560
    ds_read_b64_tr_b16 v[188:189], v57 offset:512
    ds_read_b64_tr_b16 v[174:175], v57 offset:2688
    ds_read_b64_tr_b16 v[190:191], v57 offset:640
    v_mov_b32 v224, -1
    v_mov_b32 v225, -1
    v_mov_b32 v226, -1
    v_mov_b32 v227, -1
    s_waitcnt lgkmcnt(0)
    v_mfma_f32_32x32x16_bf16 v[192:207], v[160:163], v[176:179], 0
    v_mfma_f32_32x32x16_bf16 v[192:207], v[164:167], v[180:183], v[192:207]
    v_mfma_f32_32x32x16_bf16 v[192:207], v[168:171], v[184:187], v[192:207]
    v_mfma_f32_32x32x16_bf16 v[192:207], v[172:175], v[188:191], v[192:207]
    s_mov_b32 s84, 1
    s_waitcnt vmcnt(0)
    v_mov_b32 v14, 163552
    v_mov_b32 v15, 1
    s_mov_b64 exec, 1
    ds_add_u32 v14, v15 offset:4
    s_mov_b64 exec, -1
    s_mov_b32 s85, 0x200000
L_lw1:
    ds_read_b32 v15, v14 offset:4
    s_waitcnt lgkmcnt(0)
    v_cmp_gt_u32 vcc, 8, v15
    s_sub_u32 s85, s85, 1
    s_cbranch_scc1 L_lo1
    s_cbranch_vccz L_lo1
    s_sleep 1
    s_branch L_lw1
L_lo1:
    ds_read_b128 v[20:23], v58
    ds_read_b128 v[16:19], v58 offset:1024
    ds_read_b64 v[12:13], v59 offset:2048
    ds_read_b128 v[128:131], v27
    ds_read_b128 v[136:139], v28
    ds_read_b128 v[140:143], v28 offset:512
    ds_read_b32 v25, v26 offset:128
    s_mul_i32 s73, s77, 3072
    s_add_u32 s73, s73, 131072
    buffer_atomic_add_f32 v192, v60, s[40:43], s73 offen offset:0
    buffer_atomic_add_f32 v193, v60, s[40:43], s73 offen offset:128
    buffer_atomic_add_f32 v194, v60, s[40:43], s73 offen offset:256
    buffer_atomic_add_f32 v195, v60, s[40:43], s73 offen offset:384
    buffer_atomic_add_f32 v196, v60, s[40:43], s73 offen offset:1024
    buffer_atomic_add_f32 v197, v60, s[40:43], s73 offen offset:1152
    buffer_atomic_add_f32 v198, v60, s[40:43], s73 offen offset:1280
    buffer_atomic_add_f32 v199, v60, s[40:43], s73 offen offset:1408
    buffer_atomic_add_f32 v200, v60, s[40:43], s73 offen offset:2048
    s_lshl_b32 s74, s77, 10
    s_add_u32 s74, s74, s98
    s_add_u32 s75, s74, 0
    buffer_store_dwordx4 v[224:227], v4, s[40:43], s75 offen sc1
    s_add_u32 s75, s74, 32768
    buffer_store_dwordx4 v[224:227], v4, s[40:43], s75 offen sc1
    s_add_u32 s75, s74, 2097152
    buffer_store_dwordx4 v[224:227], v4, s[40:43], s75 offen sc1
    s_add_u32 s75, s74, 2129920
    buffer_store_dwordx4 v[224:227], v4, s[40:43], s75 offen sc1
    s_waitcnt lgkmcnt(0)
    v_mov_b32 v30, v13
    v_mov_b32 v31, v12
    s_setprio 0
    s_branch L_astart
L_hook:
    s_cmp_lg_u32 s62, 0
    s_cbranch_scc1 L_hs
    s_cmp_eq_u32 s66, 2
    s_cbranch_scc1 L_h2
    s_cmp_eq_u32 s66, 3
    s_cbranch_scc1 L_h3
    s_cmp_eq_u32 s66, 4
    s_cbranch_scc1 L_h4
    s_cmp_eq_u32 s66, 5
    s_cbranch_scc1 L_h5
    s_cmp_eq_u32 s66, 6
    s_cbranch_scc1 L_h6
    s_cmp_eq_u32 s66, 7
    s_cbranch_scc1 L_h7
    s_cmp_eq_u32 s66, 8
    s_cbranch_scc1 L_h8
    s_cmp_eq_u32 s66, 9
    s_cbranch_scc1 L_h9
    s_cmp_eq_u32 s66, 10
    s_cbranch_scc1 L_h10
    s_mov_b32 s85, 0x200000
L_lw2:
    ds_read_b32 v15, v14 offset:4
    s_waitcnt lgkmcnt(0)
    v_cmp_gt_u32 vcc, 8, v15
    s_sub_u32 s85, s85, 1
    s_cbranch_scc1 L_lo2
    s_cbranch_vccz L_lo2
    s_sleep 1
    s_branch L_lw2
L_lo2:
    s_setprio 2
    ds_read_b32 v25, v26
    ds_read_b32 v26, v26 offset:128
    s_lshl_b32 s75, s61, 17
    s_add_u32 s75, s75, 0
    s_mov_b32 m0, s99
    s_nop 0
    buffer_load_dwordx4 v9, s[56:59], s75 offen offset:0 lds
    s_add_u32 s75, s75, 7168
    buffer_load_dwordx4 v9, s[56:59], s75 offen offset:1024 lds
    s_add_u32 s75, s75, 7168
    buffer_load_dwordx4 v9, s[56:59], s75 offen offset:2048 lds
    s_add_u32 s75, s75, 7168
    buffer_load_dwordx4 v9, s[56:59], s75 offen offset:3072 lds
    s_branch L_hookret
L_h2:
    v_max3_f32 v232, v192, v193, v194
    v_max3_f32 v232, v232, v195, v196
    v_max3_f32 v232, v232, v197, v198
    v_max_f32 v232, v232, v199
    v_max3_f32 v234, v200, v201, v202
    v_max3_f32 v234, v234, v203, v204
    v_max3_f32 v234, v234, v205, v206
    v_max_f32 v234, v234, v207
    s_nop 1
    v_permlane32_swap_b32 v232, v234
    v_max_f32 v232, v232, v234
    v_mul_f32 v232, s80, v232
    v_mov_b32 v234, v232
    s_nop 1
    v_permlane32_swap_b32 v232, v234
    v_pk_fma_f32 v[192:193], v[192:193], s[80:81], v[232:233] op_sel_hi:[1,1,0] neg_lo:[0,0,1] neg_hi:[0,0,1]
    v_pk_fma_f32 v[194:195], v[194:195], s[80:81], v[232:233] op_sel_hi:[1,1,0] neg_lo:[0,0,1] neg_hi:[0,0,1]
    v_pk_fma_f32 v[196:197], v[196:197], s[80:81], v[232:233] op_sel_hi:[1,1,0] neg_lo:[0,0,1] neg_hi:[0,0,1]
    v_pk_fma_f32 v[198:199], v[198:199], s[80:81], v[232:233] op_sel_hi:[1,1,0] neg_lo:[0,0,1] neg_hi:[0,0,1]
    v_pk_fma_f32 v[200:201], v[200:201], s[80:81], v[234:235] op_sel_hi:[1,1,0] neg_lo:[0,0,1] neg_hi:[0,0,1]
    v_pk_fma_f32 v[202:203], v[202:203], s[80:81], v[234:235] op_sel_hi:[1,1,0] neg_lo:[0,0,1] neg_hi:[0,0,1]
    v_pk_fma_f32 v[204:205], v[204:205], s[80:81], v[234:235] op_sel_hi:[1,1,0] neg_lo:[0,0,1] neg_hi:[0,0,1]
    v_pk_fma_f32 v[206:207], v[206:207], s[80:81], v[234:235] op_sel_hi:[1,1,0] neg_lo:[0,0,1] neg_hi:[0,0,1]
    v_exp_f32 v192, v192
    v_exp_f32 v193, v193
    v_exp_f32 v194, v194
    v_exp_f32 v195, v195
    v_exp_f32 v196, v196
    v_exp_f32 v197, v197
    v_exp_f32 v198, v198
    v_exp_f32 v199, v199
    v_exp_f32 v200, v200
    v_exp_f32 v201, v201
    v_exp_f32 v202, v202
    v_exp_f32 v203, v203
    v_exp_f32 v204, v204
    v_exp_f32 v205, v205
    v_exp_f32 v206, v206
    v_exp_f32 v207, v207
    v_pk_add_f32 v[236:237], v[192:193], v[194:195]
    v_pk_add_f32 v[238:239], v[196:197], v[198:199]
    v_pk_add_f32 v[236:237], v[236:237], v[238:239]
    v_add_f32 v232, v236, v237
    v_pk_add_f32 v[236:237], v[200:201], v[202:203]
    v_pk_add_f32 v[238:239], v[204:205], v[206:207]
    v_pk_add_f32 v[236:237], v[236:237], v[238:239]
    v_add_f32 v234, v236, v237
    s_nop 1
    v_permlane32_swap_b32 v232, v234
    v_add_f32 v232, v232, v234
    v_rcp_f32 v232, v232
    s_nop 0
    v_mov_b32 v234, v232
    s_nop 1
    v_permlane32_swap_b32 v232, v234
    v_pk_mul_f32 v[192:193], v[192:193], v[232:233] op_sel_hi:[1,0]
    v_pk_mul_f32 v[194:195], v[194:195], v[232:233] op_sel_hi:[1,0]
    v_pk_mul_f32 v[196:197], v[196:197], v[232:233] op_sel_hi:[1,0]
    v_pk_mul_f32 v[198:199], v[198:199], v[232:233] op_sel_hi:[1,0]
    v_pk_mul_f32 v[200:201], v[200:201], v[234:235] op_sel_hi:[1,0]
    v_pk_mul_f32 v[202:203], v[202:203], v[234:235] op_sel_hi:[1,0]
    v_pk_mul_f32 v[204:205], v[204:205], v[234:235] op_sel_hi:[1,0]
    v_pk_mul_f32 v[206:207], v[206:207], v[234:235] op_sel_hi:[1,0]
    v_cvt_pk_bf16_f32 v240, v192, v193
    v_cvt_pk_bf16_f32 v241, v194, v195
    v_cvt_pk_bf16_f32 v242, v196, v197
    v_cvt_pk_bf16_f32 v243, v198, v199
    v_cvt_pk_bf16_f32 v244, v200, v201
    v_cvt_pk_bf16_f32 v245, v202, v203
    v_cvt_pk_bf16_f32 v246, v204, v205
    v_cvt_pk_bf16_f32 v247, v206, v207
    s_waitcnt vmcnt(0)
    ds_read_b64_tr_b16 v[160:161], v10 offset:0
    ds_read_b64_tr_b16 v[162:163], v10 offset:512
    ds_read_b64_tr_b16 v[164:165], v11 offset:0
    ds_read_b64_tr_b16 v[166:167], v11 offset:512
    ds_read_b64_tr_b16 v[168:169], v10 offset:2048
    ds_read_b64_tr_b16 v[170:171], v10 offset:2560
    ds_read_b64_tr_b16 v[172:173], v11 offset:2048
    ds_read_b64_tr_b16 v[174:175], v11 offset:2560
    s_waitcnt lgkmcnt(0)
    s_lshl_b32 s75, s61, 17
    s_add_u32 s75, s75, 32768
    s_mov_b32 m0, s99
    s_nop 0
    buffer_load_dwordx4 v9, s[56:59], s75 offen offset:0 lds
    s_add_u32 s75, s75, 7168
    buffer_load_dwordx4 v9, s[56:59], s75 offen offset:1024 lds
    s_add_u32 s75, s75, 7168
    buffer_load_dwordx4 v9, s[56:59], s75 offen offset:2048 lds
    s_add_u32 s75, s75, 7168
    buffer_load_dwordx4 v9, s[56:59], s75 offen offset:3072 lds
    s_branch L_hookret
L_h3:
    v_max3_f32 v232, v208, v209, v210
    v_max3_f32 v232, v232, v211, v212
    v_max3_f32 v232, v232, v213, v214
    v_max_f32 v232, v232, v215
    v_max3_f32 v234, v216, v217, v218
    v_max3_f32 v234, v234, v219, v220
    v_max3_f32 v234, v234, v221, v222
    v_max_f32 v234, v234, v223
    s_nop 1
    v_permlane32_swap_b32 v232, v234
    v_max_f32 v232, v232, v234
    v_mul_f32 v232, s80, v232
    v_mov_b32 v234, v232
    s_nop 1
    v_permlane32_swap_b32 v232, v234
    v_pk_fma_f32 v[208:209], v[208:209], s[80:81], v[232:233] op_sel_hi:[1,1,0] neg_lo:[0,0,1] neg_hi:[0,0,1]
    v_pk_fma_f32 v[210:211], v[210:211], s[80:81], v[232:233] op_sel_hi:[1,1,0] neg_lo:[0,0,1] neg_hi:[0,0,1]
    v_pk_fma_f32 v[212:213], v[212:213], s[80:81], v[232:233] op_sel_hi:[1,1,0] neg_lo:[0,0,1] neg_hi:[0,0,1]
    v_pk_fma_f32 v[214:215], v[214:215], s[80:81], v[232:233] op_sel_hi:[1,1,0] neg_lo:[0,0,1] neg_hi:[0,0,1]
    v_pk_fma_f32 v[216:217], v[216:217], s[80:81], v[234:235] op_sel_hi:[1,1,0] neg_lo:[0,0,1] neg_hi:[0,0,1]
    v_pk_fma_f32 v[218:219], v[218:219], s[80:81], v[234:235] op_sel_hi:[1,1,0] neg_lo:[0,0,1] neg_hi:[0,0,1]
    v_pk_fma_f32 v[220:221], v[220:221], s[80:81], v[234:235] op_sel_hi:[1,1,0] neg_lo:[0,0,1] neg_hi:[0,0,1]
    v_pk_fma_f32 v[222:223], v[222:223], s[80:81], v[234:235] op_sel_hi:[1,1,0] neg_lo:[0,0,1] neg_hi:[0,0,1]
    v_exp_f32 v208, v208
    v_exp_f32 v209, v209
    v_exp_f32 v210, v210
    v_exp_f32 v211, v211
    v_exp_f32 v212, v212
    v_exp_f32 v213, v213
    v_exp_f32 v214, v214
    v_exp_f32 v215, v215
    v_exp_f32 v216, v216
    v_exp_f32 v217, v217
    v_exp_f32 v218, v218
    v_exp_f32 v219, v219
    v_exp_f32 v220, v220
    v_exp_f32 v221, v221
    v_exp_f32 v222, v222
    v_exp_f32 v223, v223
    v_pk_add_f32 v[236:237], v[208:209], v[210:211]
    v_pk_add_f32 v[238:239], v[212:213], v[214:215]
    v_pk_add_f32 v[236:237], v[236:237], v[238:239]
    v_add_f32 v232, v236, v237
    v_pk_add_f32 v[236:237], v[216:217], v[218:219]
    v_pk_add_f32 v[238:239], v[220:221], v[222:223]
    v_pk_add_f32 v[236:237], v[236:237], v[238:239]
    v_add_f32 v234, v236, v237
    s_nop 1
    v_permlane32_swap_b32 v232, v234
    v_add_f32 v232, v232, v234
    v_rcp_f32 v232, v232
    s_nop 0
    v_mov_b32 v234, v232
    s_nop 1
    v_permlane32_swap_b32 v232, v234
    v_pk_mul_f32 v[208:209], v[208:209], v[232:233] op_sel_hi:[1,0]
    v_pk_mul_f32 v[210:211], v[210:211], v[232:233] op_sel_hi:[1,0]
    v_pk_mul_f32 v[212:213], v[212:213], v[232:233] op_sel_hi:[1,0]
    v_pk_mul_f32 v[214:215], v[214:215], v[232:233] op_sel_hi:[1,0]
    v_pk_mul_f32 v[216:217], v[216:217], v[234:235] op_sel_hi:[1,0]
    v_pk_mul_f32 v[218:219], v[218:219], v[234:235] op_sel_hi:[1,0]
    v_pk_mul_f32 v[220:221], v[220:221], v[234:235] op_sel_hi:[1,0]
    v_pk_mul_f32 v[222:223], v[222:223], v[234:235] op_sel_hi:[1,0]
    v_cvt_pk_bf16_f32 v248, v208, v209
    v_cvt_pk_bf16_f32 v249, v210, v211
    v_cvt_pk_bf16_f32 v250, v212, v213
    v_cvt_pk_bf16_f32 v251, v214, v215
    v_cvt_pk_bf16_f32 v252, v216, v217
    v_cvt_pk_bf16_f32 v253, v218, v219
    v_cvt_pk_bf16_f32 v254, v220, v221
    v_cvt_pk_bf16_f32 v255, v222, v223
    s_waitcnt vmcnt(0)
    ds_read_b64_tr_b16 v[176:177], v10 offset:0
    ds_read_b64_tr_b16 v[178:179], v10 offset:512
    ds_read_b64_tr_b16 v[180:181], v11 offset:0
    ds_read_b64_tr_b16 v[182:183], v11 offset:512
    ds_read_b64_tr_b16 v[184:185], v10 offset:2048
    ds_read_b64_tr_b16 v[186:187], v10 offset:2560
    ds_read_b64_tr_b16 v[188:189], v11 offset:2048
    ds_read_b64_tr_b16 v[190:191], v11 offset:2560
    s_waitcnt lgkmcnt(0)
    s_lshl_b32 s75, s61, 17
    s_add_u32 s75, s75, 65536
    s_mov_b32 m0, s99
    s_nop 0
    buffer_load_dwordx4 v9, s[56:59], s75 offen offset:0 lds
    s_add_u32 s75, s75, 7168
    buffer_load_dwordx4 v9, s[56:59], s75 offen offset:1024 lds
    s_add_u32 s75, s75, 7168
    buffer_load_dwordx4 v9, s[56:59], s75 offen offset:2048 lds
    s_add_u32 s75, s75, 7168
    buffer_load_dwordx4 v9, s[56:59], s75 offen offset:3072 lds
    s_branch L_hookret
L_h4:
    s_waitcnt vmcnt(0)
    ds_read_b64_tr_b16 v[192:193], v10 offset:0
    ds_read_b64_tr_b16 v[194:195], v10 offset:512
    ds_read_b64_tr_b16 v[196:197], v11 offset:0
    ds_read_b64_tr_b16 v[198:199], v11 offset:512
    ds_read_b64_tr_b16 v[200:201], v10 offset:2048
    ds_read_b64_tr_b16 v[202:203], v10 offset:2560
    ds_read_b64_tr_b16 v[204:205], v11 offset:2048
    ds_read_b64_tr_b16 v[206:207], v11 offset:2560
    s_waitcnt lgkmcnt(0)
    s_lshl_b32 s75, s61, 17
    s_add_u32 s75, s75, 98304
    s_mov_b32 m0, s99
    s_nop 0
    buffer_load_dwordx4 v9, s[56:59], s75 offen offset:0 lds
    s_add_u32 s75, s75, 7168
    buffer_load_dwordx4 v9, s[56:59], s75 offen offset:1024 lds
    s_add_u32 s75, s75, 7168
    buffer_load_dwordx4 v9, s[56:59], s75 offen offset:2048 lds
    s_add_u32 s75, s75, 7168
    buffer_load_dwordx4 v9, s[56:59], s75 offen offset:3072 lds
    s_branch L_hookret
L_h5:
    s_waitcnt vmcnt(0)
    ds_read_b64_tr_b16 v[208:209], v10 offset:0
    ds_read_b64_tr_b16 v[210:211], v10 offset:512
    ds_read_b64_tr_b16 v[212:213], v11 offset:0
    ds_read_b64_tr_b16 v[214:215], v11 offset:512
    ds_read_b64_tr_b16 v[216:217], v10 offset:2048
    ds_read_b64_tr_b16 v[218:219], v10 offset:2560
    ds_read_b64_tr_b16 v[220:221], v11 offset:2048
    ds_read_b64_tr_b16 v[222:223], v11 offset:2560
    s_waitcnt lgkmcnt(0)
    s_branch L_hookret
L_h6:
    s_lshl_b32 s73, s77, 7
    s_lshl_b32 s74, s14, 7
    s_add_u32 s74, s74, 4096
    s_sub_u32 s74, s74, s73
    s_add_u32 s76, s73, 229376
    v_mul_lo_u32 v13, v3, s74
    buffer_load_dword v12, v13, s[40:43], s76 offen sc1
    s_branch L_hookret
L_h7:
    s_mov_b32 s85, 0x40000
L_d2poll:
    s_waitcnt vmcnt(0)
    v_cmp_gt_u32 vcc, 32, v12
    s_sub_u32 s85, s85, 1
    s_cbranch_scc1 L_d2out
    s_cbranch_vccz L_d2out
    s_sleep 4
    buffer_load_dword v12, v13, s[40:43], s76 offen sc1
    s_branch L_d2poll
L_d2out:
    v_lshlrev_b32 v13, 7, v2
    v_lshl_add_u32 v13, v3, 5, v13
    s_mul_i32 s73, s77, 3072
    s_add_u32 s73, s73, 131072
    buffer_load_dwordx4 v[224:227], v13, s[40:43], s73 offen offset:0 sc1
    buffer_load_dwordx4 v[228:231], v13, s[40:43], s73 offen offset:16 sc1
    buffer_load_dwordx4 v[232:235], v13, s[40:43], s73 offen offset:64 sc1
    buffer_load_dwordx4 v[236:239], v13, s[40:43], s73 offen offset:80 sc1
    s_branch L_hookret
L_h8:
    s_waitcnt vmcnt(0)
    v_cvt_pk_bf16_f32 v152, v224, v225
    v_cvt_pk_bf16_f32 v153, v226, v227
    v_cvt_pk_bf16_f32 v154, v228, v229
    v_cvt_pk_bf16_f32 v155, v230, v231
    v_cvt_pk_bf16_f32 v156, v232, v233
    v_cvt_pk_bf16_f32 v157, v234, v235
    v_cvt_pk_bf16_f32 v158, v236, v237
    v_cvt_pk_bf16_f32 v159, v238, v239
    s_lshl_b32 s74, s77, 10
    s_add_u32 s74, s98, s74
    v_mfma_f32_32x32x16_bf16 v[224:239], v[152:155], v[240:243], 0
    v_mfma_f32_32x32x16_bf16 v[224:239], v[156:159], v[244:247], v[224:239]
    s_nop 11
    v_add_f32 v30, 897988541, v232
    v_rcp_f32 v30, v30
    s_nop 0
    v_mul_f32 v30, v30, v25
    v_pk_mul_f32 v[224:225], v[224:225], v[30:31] op_sel_hi:[1,0]
    v_pk_mul_f32 v[226:227], v[226:227], v[30:31] op_sel_hi:[1,0]
    v_pk_mul_f32 v[228:229], v[228:229], v[30:31] op_sel_hi:[1,0]
    v_pk_mul_f32 v[230:231], v[230:231], v[30:31] op_sel_hi:[1,0]
    v_cvt_pk_bf16_f32 v240, v224, v225
    v_cvt_pk_bf16_f32 v241, v226, v227
    v_cvt_pk_bf16_f32 v242, v228, v229
    v_cvt_pk_bf16_f32 v243, v230, v231
    v_min_u32 v240, -2, v240
    v_min_u32 v241, -2, v241
    v_min_u32 v242, -2, v242
    v_min_u32 v243, -2, v243
    buffer_store_dwordx4 v[240:243], v4, s[40:43], s74 offen sc1
    s_add_u32 s74, s74, 32768
    v_mfma_f32_32x32x16_bf16 v[224:239], v[152:155], v[248:251], 0
    v_mfma_f32_32x32x16_bf16 v[224:239], v[156:159], v[252:255], v[224:239]
    s_nop 11
    v_add_f32 v30, 897988541, v232
    v_rcp_f32 v30, v30
    s_nop 0
    v_mul_f32 v30, v30, v26
    v_pk_mul_f32 v[224:225], v[224:225], v[30:31] op_sel_hi:[1,0]
    v_pk_mul_f32 v[226:227], v[226:227], v[30:31] op_sel_hi:[1,0]
    v_pk_mul_f32 v[228:229], v[228:229], v[30:31] op_sel_hi:[1,0]
    v_pk_mul_f32 v[230:231], v[230:231], v[30:31] op_sel_hi:[1,0]
    v_cvt_pk_bf16_f32 v248, v224, v225
    v_cvt_pk_bf16_f32 v249, v226, v227
    v_cvt_pk_bf16_f32 v250, v228, v229
    v_cvt_pk_bf16_f32 v251, v230, v231
    v_min_u32 v248, -2, v248
    v_min_u32 v249, -2, v249
    v_min_u32 v250, -2, v250
    v_min_u32 v251, -2, v251
    buffer_store_dwordx4 v[248:251], v4, s[40:43], s74 offen sc1
    v_mov_b32 v5, 163552
    v_mov_b32 v6, 1
    s_mov_b64 exec, 1
    ds_add_u32 v5, v6
    s_mov_b64 exec, -1
    s_branch L_hookret
L_h9:
    s_mov_b32 s85, 0x400000
L_pw:
    ds_read_b32 v6, v5
    s_waitcnt lgkmcnt(0)
    v_cmp_gt_u32 vcc, 4, v6
    s_sub_u32 s85, s85, 1
    s_cbranch_scc1 L_pwout
    s_cbranch_vccz L_pwout
    s_sleep 1
    s_branch L_pw
L_pwout:
    s_mov_b32 s56, s20
    s_mov_b32 s57, s21
    s_mov_b32 s58, 524288
    s_mov_b32 s59, 0x20000
    s_lshl_b32 s75, s61, 17
    s_sub_u32 s73, s31, s99
    v_add_u32 v10, s73, v10
    v_add_u32 v11, s73, v11
    s_add_u32 m0, s31, 0
    s_nop 0
    buffer_load_dwordx4 v9, s[56:59], s75 offen offset:0 lds
    s_add_u32 s75, s75, 7168
    buffer_load_dwordx4 v9, s[56:59], s75 offen offset:1024 lds
    s_add_u32 s75, s75, 7168
    buffer_load_dwordx4 v9, s[56:59], s75 offen offset:2048 lds
    s_add_u32 s75, s75, 7168
    buffer_load_dwordx4 v9, s[56:59], s75 offen offset:3072 lds
    s_add_u32 m0, s31, 4096
    s_add_u32 s75, s75, 11264
    buffer_load_dwordx4 v9, s[56:59], s75 offen offset:0 lds
    s_add_u32 s75, s75, 7168
    buffer_load_dwordx4 v9, s[56:59], s75 offen offset:1024 lds
    s_add_u32 s75, s75, 7168
    buffer_load_dwordx4 v9, s[56:59], s75 offen offset:2048 lds
    s_add_u32 s75, s75, 7168
    buffer_load_dwordx4 v9, s[56:59], s75 offen offset:3072 lds
    s_add_u32 m0, s31, 8192
    s_add_u32 s75, s75, 11264
    buffer_load_dwordx4 v9, s[56:59], s75 offen offset:0 lds
    s_add_u32 s75, s75, 7168
    buffer_load_dwordx4 v9, s[56:59], s75 offen offset:1024 lds
    s_add_u32 s75, s75, 7168
    buffer_load_dwordx4 v9, s[56:59], s75 offen offset:2048 lds
    s_add_u32 s75, s75, 7168
    buffer_load_dwordx4 v9, s[56:59], s75 offen offset:3072 lds
    s_add_u32 m0, s31, 12288
    s_add_u32 s75, s75, 11264
    buffer_load_dwordx4 v9, s[56:59], s75 offen offset:0 lds
    s_add_u32 s75, s75, 7168
    buffer_load_dwordx4 v9, s[56:59], s75 offen offset:1024 lds
    s_add_u32 s75, s75, 7168
    buffer_load_dwordx4 v9, s[56:59], s75 offen offset:2048 lds
    s_add_u32 s75, s75, 7168
    buffer_load_dwordx4 v9, s[56:59], s75 offen offset:3072 lds
    s_branch L_hookret
L_h10:
    s_lshl_b32 s73, s61, 13
    s_add_u32 s73, s73, s16
    s_add_u32 s73, s73, 32768
    s_add_u32 s76, s73, 4096
    buffer_load_dwordx4 v[224:227], v4, s[40:43], s73 offen offset:0 sc1
    buffer_load_dwordx4 v[228:231], v4, s[40:43], s73 offen offset:1024 sc1
    buffer_load_dwordx4 v[232:235], v4, s[40:43], s73 offen offset:2048 sc1
    buffer_load_dwordx4 v[236:239], v4, s[40:43], s73 offen offset:3072 sc1
    buffer_load_dwordx4 v[240:243], v4, s[40:43], s76 offen offset:0 sc1
    buffer_load_dwordx4 v[244:247], v4, s[40:43], s76 offen offset:1024 sc1
    buffer_load_dwordx4 v[248:251], v4, s[40:43], s76 offen offset:2048 sc1
    buffer_load_dwordx4 v[252:255], v4, s[40:43], s76 offen offset:3072 sc1
    s_branch L_hookret
L_hs:
    s_setprio 1
    s_lshl_b32 s73, s77, 7
    s_lshl_b32 s74, s63, 7
    s_add_u32 s74, s74, 4096
    s_sub_u32 s74, s74, s73
    s_add_u32 s73, s73, 229376
    v_mul_lo_u32 v13, v1, s74
    v_mov_b32 v12, 1
    s_waitcnt vmcnt(0)
    s_mov_b64 exec, 3
    buffer_atomic_add v12, v13, s[40:43], s73 offen sc1
    s_mov_b64 exec, -1
    s_mov_b32 s48, s20
    s_mov_b32 s49, s21
    s_mov_b32 s50, 524288
    s_mov_b32 s51, 0x20000
    s_and_b32 s73, s14, 3
    s_lshl_b32 s73, s73, 17
    s_lshl_b32 s75, s61, 15
    s_add_u32 s73, s73, s75
    buffer_load_dwordx4 v[224:227], v9, s[48:51], s73 offen
    s_add_u32 s73, s73, 8192
    buffer_load_dwordx4 v[228:231], v9, s[48:51], s73 offen
    s_add_u32 s73, s73, 8192
    buffer_load_dwordx4 v[232:235], v9, s[48:51], s73 offen
    s_add_u32 s73, s73, 8192
    buffer_load_dwordx4 v[236:239], v9, s[48:51], s73 offen
    s_add_u32 s73, s73, 8192
    s_branch L_hookret
L_are1:
    s_lshl_b32 s73, s61, 13
    s_add_u32 s73, s73, s16
    s_add_u32 s73, s73, 32768
    s_add_u32 s76, s73, 4096
    buffer_load_dwordx4 v[224:227], v4, s[40:43], s73 offen offset:0 sc1
    buffer_load_dwordx4 v[228:231], v4, s[40:43], s73 offen offset:1024 sc1
    buffer_load_dwordx4 v[232:235], v4, s[40:43], s73 offen offset:2048 sc1
    buffer_load_dwordx4 v[236:239], v4, s[40:43], s73 offen offset:3072 sc1
    buffer_load_dwordx4 v[240:243], v4, s[40:43], s76 offen offset:0 sc1
    buffer_load_dwordx4 v[244:247], v4, s[40:43], s76 offen offset:1024 sc1
    buffer_load_dwordx4 v[248:251], v4, s[40:43], s76 offen offset:2048 sc1
    buffer_load_dwordx4 v[252:255], v4, s[40:43], s76 offen offset:3072 sc1
    s_waitcnt vmcnt(0)
    s_branch L_achk1
L_are0:
    s_lshl_b32 s73, s61, 13
    s_add_u32 s73, s73, s16
    s_add_u32 s73, s73, 0
    s_add_u32 s76, s73, 4096
    buffer_load_dwordx4 v[32:35], v4, s[40:43], s73 offen offset:0 sc1
    buffer_load_dwordx4 v[36:39], v4, s[40:43], s73 offen offset:1024 sc1
    buffer_load_dwordx4 v[40:43], v4, s[40:43], s73 offen offset:2048 sc1
    buffer_load_dwordx4 v[44:47], v4, s[40:43], s73 offen offset:3072 sc1
    buffer_load_dwordx4 v[48:51], v4, s[40:43], s76 offen offset:0 sc1
    buffer_load_dwordx4 v[52:55], v4, s[40:43], s76 offen offset:1024 sc1
    buffer_load_dwordx4 v[56:59], v4, s[40:43], s76 offen offset:2048 sc1
    buffer_load_dwordx4 v[60:63], v4, s[40:43], s76 offen offset:3072 sc1
    s_waitcnt vmcnt(0)
    s_branch L_achk0
L_fallback:
    v_mov_b32 v12, 0xff800000
    s_mov_b32 s65, 0
L_fb1:
    buffer_load_dwordx4 v[112:115], v4, s[40:43], s65 offen sc1
    s_waitcnt vmcnt(0)
    v_mfma_f32_32x32x16_bf16 v[96:111], v[112:115], v[16:19], 0
    s_nop 11
    v_max3_f32 v12, v12, v96, v97
    v_max3_f32 v12, v12, v98, v99
    v_max3_f32 v12, v12, v100, v101
    v_max3_f32 v12, v12, v102, v103
    v_max3_f32 v12, v12, v104, v105
    v_max3_f32 v12, v12, v106, v107
    v_max3_f32 v12, v12, v108, v109
    v_max3_f32 v12, v12, v110, v111
    s_add_u32 s65, s65, 1024
    s_cmp_lt_u32 s65, 65536
    s_cbranch_scc1 L_fb1
    v_mov_b32 v13, v12
    s_nop 1
    v_permlane32_swap_b32 v12, v13
    v_max_f32 v12, v12, v13
    v_sub_f32 v12, 0, v12
    v_mov_b32 v224, v12
    v_mov_b32 v64, 0
    v_mov_b32 v225, v12
    v_mov_b32 v65, 0
    v_mov_b32 v226, v12
    v_mov_b32 v66, 0
    v_mov_b32 v227, v12
    v_mov_b32 v67, 0
    v_mov_b32 v228, v12
    v_mov_b32 v68, 0
    v_mov_b32 v229, v12
    v_mov_b32 v69, 0
    v_mov_b32 v230, v12
    v_mov_b32 v70, 0
    v_mov_b32 v231, v12
    v_mov_b32 v71, 0
    v_mov_b32 v232, v12
    v_mov_b32 v72, 0
    v_mov_b32 v233, v12
    v_mov_b32 v73, 0
    v_mov_b32 v234, v12
    v_mov_b32 v74, 0
    v_mov_b32 v235, v12
    v_mov_b32 v75, 0
    v_mov_b32 v236, v12
    v_mov_b32 v76, 0
    v_mov_b32 v237, v12
    v_mov_b32 v77, 0
    v_mov_b32 v238, v12
    v_mov_b32 v78, 0
    v_mov_b32 v239, v12
    v_mov_b32 v79, 0
    v_mov_b32 v116, 0x3f803f80
    v_mov_b32 v117, 0x3f803f80
    v_mov_b32 v118, 0x3f803f80
    v_mov_b32 v119, 0x3f803f80
    v_mov_b32 v120, 0x3f803f80
    v_mov_b32 v121, 0x3f803f80
    v_mov_b32 v122, 0x3f803f80
    v_mov_b32 v123, 0x3f803f80
    v_and_b32 v5, 15, v1
    v_lshlrev_b32 v5, 4, v5
    v_lshl_add_u32 v5, v3, 8, v5
    v_add_u32 v5, 65536, v5
    s_mov_b32 s65, 0
L_fb2:
    buffer_load_dwordx4 v[112:115], v4, s[40:43], s65 offen sc1
    s_mov_b64 exec, s[82:83]
    buffer_load_dwordx4 v[116:119], v5, s[40:43], s65 offen sc1
    buffer_load_dwordx4 v[120:123], v5, s[40:43], s65 offen offset:512 sc1
    s_mov_b64 exec, -1
    s_waitcnt vmcnt(0)
    v_mfma_f32_32x32x16_bf16 v[96:111], v[112:115], v[16:19], v[224:239]
    s_nop 11
    v_exp_f32 v96, v96
    v_exp_f32 v97, v97
    v_exp_f32 v98, v98
    v_exp_f32 v99, v99
    v_exp_f32 v100, v100
    v_exp_f32 v101, v101
    v_exp_f32 v102, v102
    v_exp_f32 v103, v103
    v_exp_f32 v104, v104
    v_exp_f32 v105, v105
    v_exp_f32 v106, v106
    v_exp_f32 v107, v107
    v_exp_f32 v108, v108
    v_exp_f32 v109, v109
    v_exp_f32 v110, v110
    v_exp_f32 v111, v111
    s_nop 1
    v_smfmac_f32_32x32x32_bf16 v[64:79], v[116:119], v[96:103], v24
    v_smfmac_f32_32x32x32_bf16 v[64:79], v[120:123], v[104:111], v24
    s_add_u32 s65, s65, 1024
    s_cmp_lt_u32 s65, 65536
    s_cbranch_scc1 L_fb2
    s_nop 11
    v_mov_b32 v224, -1
    s_branch L_fbret
L_codeend:
.section .rodata,"a"
.p2align 6
.amdhsa_kernel gated_mix__linear_kernel_hedgehog__grouped_kv_mqa__prompt_kernel
  .amdhsa_next_free_vgpr 256
  .amdhsa_next_free_sgpr 102
  .amdhsa_accum_offset 256
  .amdhsa_group_segment_fixed_size 0
  .amdhsa_kernarg_size 104
  .amdhsa_user_sgpr_count 2
  .amdhsa_user_sgpr_kernarg_segment_ptr 1
  .amdhsa_system_sgpr_workgroup_id_x 1
.end_amdhsa_kernel
```
